```python
import torch

def _softmax(x, axis=-1):
    return torch.softmax(x, dim=axis)

def _gelu(x):
    return torch.nn.functional.gelu(x, approximate='tanh')

def _silu(x):
    return torch.nn.functional.silu(x)

def _sigmoid(x):
    return torch.sigmoid(x)

def _layernorm(x, axis=-1, eps=1e-05):
    m = x.mean(dim=axis, keepdim=True)
    v = x.var(dim=axis, keepdim=True, unbiased=False)
    return (x - m) / torch.sqrt(v + eps)

def _scatter_add(tgt, idx, src, axis=0):
    return tgt.clone().index_add_(axis, idx, src)

def _segment_sum(src, seg, n):
    out = torch.zeros((n,) + src.shape[1:], dtype=src.dtype)
    return out.index_add_(0, seg, src)

def _pad(x, pw):
    flat = tuple((v for pair in reversed(pw) for v in pair))
    return torch.nn.functional.pad(x, flat)
kernel_name = 'standalone__video_timesformer__vision'

def setup_inputs():

    _w = lambda a: (lambda t: t.to(torch.bfloat16) if t.is_floating_point() else t)(torch.as_tensor(a))
    T = 7
    p = 14
    HW = 384 // p * p
    N = (HW // p) ** 2
    C = 192
    return {'x': _w((lambda *s: torch.randn(*s, dtype=torch.bfloat16) * 0.05)(1, T, N, C)), 'wqkv_t': _w((lambda *s: torch.randn(*s, dtype=torch.bfloat16) * 0.05)(C, 3 * C)), 'wo_t': _w((lambda *s: torch.randn(*s, dtype=torch.bfloat16) * 0.05)(C, C)), 'wqkv_s': _w((lambda *s: torch.randn(*s, dtype=torch.bfloat16) * 0.05)(C, 3 * C)), 'wo_s': _w((lambda *s: torch.randn(*s, dtype=torch.bfloat16) * 0.4)(C, C))}

def reference(x, wqkv_t, wo_t, wqkv_s, wo_s):
    B, T, N, C = x.shape
    scale = C ** (-0.5)
    xt = (lambda x, *d: x.permute(*d))(x, 0, 2, 1, 3).reshape(B * N, T, C)
    h = _layernorm(xt, axis=-1)
    qkv = h @ wqkv_t
    q, k, v = (qkv[..., :C].clone(), qkv[..., C:2 * C].clone(), qkv[..., 2 * C:].clone())
    a = _softmax(torch.einsum('btc,bsc->bts', q, k) * scale, axis=-1)
    xt = xt + torch.einsum('bts,bsc->btc', a, v) @ wo_t
    x1 = (lambda x, *d: x.permute(*d))(xt.reshape(B, N, T, C), 0, 2, 1, 3)
    xs = x1.reshape(B * T, N, C)
    h = _layernorm(xs, axis=-1)
    qkv = h @ wqkv_s
    q, k, v = (qkv[..., :C].clone(), qkv[..., C:2 * C].clone(), qkv[..., 2 * C:].clone())
    a = _softmax(torch.einsum('bnc,bmc->bnm', q, k) * scale, axis=-1)
    xs = xs + torch.einsum('bnm,bmc->bnc', a, v) @ wo_s
    return xs.reshape(B, T, N, C)
```

```asm
; @launch grid=(220,1,1) block=(256,1,1) lds=161792
.amdgcn_target "amdgcn-amd-amdhsa--gfx950"
.text
.p2align 12
.globl standalone__video_timesformer__vision_kernel
.p2align 8
.type standalone__video_timesformer__vision_kernel,@function
standalone__video_timesformer__vision_kernel:
    s_load_dwordx2 s[4:5], s[0:1], 0
    s_load_dwordx2 s[8:9], s[0:1], 8
    s_load_dwordx2 s[16:17], s[0:1], 16
    s_load_dwordx2 s[20:21], s[0:1], 40
    s_load_dwordx2 s[24:25], s[0:1], 48
    s_load_dwordx2 s[12:13], s[0:1], 56
    s_cmp_ge_u32 s2, 220
    s_cbranch_scc1 L_end
    s_getpc_b64 s[28:29]
L_pc:
    s_mov_b32 s30, L_hot_end-L_pc
    s_mov_b32 s31, 0x00020000
    v_lshrrev_b32 v6, 6, v0
    v_and_b32 v1, 63, v0
    s_bfe_u32 s32, s2, 0x30003
    s_mul_i32 s32, s32, 3584
    v_readfirstlane_b32 s3, v6
    v_mad_u32_u24 v4, v6, 7, v1
    v_lshl_add_u32 v4, v4, 7, s32
    s_mov_b64 exec, 0x7f
    buffer_load_dword v254, v4, s[28:31], 0 offen
    s_mov_b64 exec, -1
    v_and_b32 v2, 15, v0
    v_bfe_u32 v3, v0, 4, 2
    v_lshlrev_b32 v32, 4, v1
    s_mov_b32 s14, 2369536
    s_mov_b32 s15, 0x00020000
    s_mov_b32 s26, 256
    s_mov_b32 s27, 0x00020000
    s_cmp_ge_u32 s2, 184
    s_cbranch_scc1 L_fold
    s_mov_b32 s6, 1959552
    s_mov_b32 s7, 0x00020000
    s_mov_b32 s10, 221184
    s_mov_b32 s11, 0x00020000
    s_mov_b32 s18, 73728
    s_mov_b32 s19, 0x00020000
    s_mov_b32 s22, 1959552
    s_mov_b32 s23, 0x00020000
    v_lshrrev_b32 v6, 3, v1
    v_and_b32_e64 v7, 7, v1
    s_lshl_b32 s32, s2, 2
    s_add_u32 s32, s32, s3
    s_mul_i32 s33, s32, 384
    s_mov_b32 s34, 279936
    v_mul_lo_u32 v8, v6, s34
    v_lshl_add_u32 v8, v7, 4, v8
    v_add_u32 v8, s33, v8
    s_cmp_lt_u32 s32, 729
    s_cselect_b32 s34, 7, 0
    v_cmp_gt_u32 vcc, s34, v6
    v_mov_b32 v9, 2147418112
    s_and_b32 s35, s3, 1
    s_lshl_b32 s36, s35, 3
    v_cndmask_b32 v192, v9, v8, vcc
    s_mul_i32 s38, s3, 9216
    s_mul_i32 s62, s3, 6144
    s_mul_i32 s63, s3, 3072
    s_waitcnt lgkmcnt(0)
    buffer_load_dwordx4 v[4:7], v192, s[4:7], 0 offen offset:0 nt
    buffer_load_dwordx4 v[8:11], v192, s[4:7], 0 offen offset:128 nt
    buffer_load_dwordx4 v[12:15], v192, s[4:7], 0 offen offset:256 nt
    v_add_u32 v18, 0, v1
    v_mul_u32_u24 v19, 683, v18
    v_lshrrev_b32 v19, 15, v19
    v_lshl_add_u32 v20, v19, 1, s36
    v_xor_b32 v20, v1, v20
    v_mul_u32_u24 v19, 384, v19
    v_lshl_add_u32 v19, v20, 4, v19
    v_add_u32 v193, s38, v19
    v_add_u32 v18, 64, v1
    v_mul_u32_u24 v19, 683, v18
    v_lshrrev_b32_e64 v19, 15, v19
    v_lshl_add_u32 v20, v19, 1, s36
    v_xor_b32 v20, v1, v20
    v_mul_u32_u24 v19, 384, v19
    v_lshl_add_u32 v19, v20, 4, v19
    v_add_u32 v194, s38, v19
    v_add_u32 v18, 128, v1
    v_mul_u32_u24 v19, 683, v18
    v_lshrrev_b32 v19, 15, v19
    v_lshl_add_u32 v20, v19, 1, s36
    v_xor_b32 v20, v1, v20
    v_mul_u32_u24 v19, 384, v19
    v_lshl_add_u32 v19, v20, 4, v19
    v_add_u32 v195, s38, v19
    s_lshr_b32 s32, s2, 3
    s_lshl_b32 s32, s32, 2
    s_add_u32 s32, s32, s3
    s_mul_i32 s33, s32, 3328
    v_lshlrev_b32 v16, 7, v1
    v_add_u32 v16, s33, v16
    v_subrev_u32 v17, 221184, v16
    v_min_u32 v17, 2147418112, v17
    s_add_u32 m0, s62, 0
    s_mov_b32 s53, 0
    buffer_load_dwordx4 v193, s[8:11], s53 offen offset:0 lds
    buffer_load_dwordx4 v194, s[8:11], s53 offen offset:1024 lds
    buffer_load_dwordx4 v195, s[8:11], s53 offen offset:2048 lds
    s_add_u32 m0, s62, 3072
    s_mov_b32 s53, 4608
    buffer_load_dwordx4 v193, s[8:11], s53 offen offset:0 lds
    buffer_load_dwordx4 v194, s[8:11], s53 offen offset:1024 lds
    buffer_load_dwordx4 v195, s[8:11], s53 offen offset:2048 lds
    s_mov_b64 exec, 0x3ffffff
    buffer_load_dword v252, v16, s[8:11], 0 offen
    buffer_load_dword v253, v17, s[16:19], 0 offen
    s_mov_b64 exec, -1
    v_lshrrev_b32 v228, 3, v1
    v_and_b32 v229, 7, v1
    v_lshlrev_b32 v229, 4, v229
    s_lshl_b32 s64, s3, 3
    v_add_u32 v230, s64, v228
    v_lshrrev_b32 v232, 3, v230
    v_xor_b32 v232, v232, v230
    v_and_b32 v232, 14, v232
    v_lshlrev_b32 v231, 3, v232
    v_mul_u32_u24 v230, 384, v230
    v_xad_u32 v230, v229, v231, v230
    v_add_u32 v211, 135168, v230
    v_add_u32 v59, 135168, v230
    v_lshl_add_u32 v230, v228, 2, s3
    v_lshrrev_b32 v232, 3, v230
    v_xor_b32 v232, v232, v230
    v_and_b32 v232, 14, v232
    v_lshlrev_b32 v231, 3, v232
    v_mul_u32_u24 v230, 384, v230
    v_add_u32 v230, 122880, v230
    v_xad_u32 v212, v229, v231, v230
    v_lshrrev_b32 v232, 3, v2
    v_xor_b32 v232, v232, v2
    v_and_b32 v232, 14, v232
    v_lshlrev_b32 v231, 3, v232
    v_mul_u32_u24 v230, 384, v2
    v_lshlrev_b32_e64 v229, 4, v3
    v_xad_u32 v233, v229, v231, v230
    v_add_u32 v213, 135168, v233
    v_xor_b32 v214, 64, v213
    v_xor_b32 v232, 16, v213
    v_add_u32 v215, 6144, v232
    v_xor_b32 v216, 64, v215
    v_xor_b32 v232, 8, v2
    v_mul_u32_u24 v232, 384, v232
    v_add_u32 v232, 141312, v232
    v_xor_b32 v234, 80, v231
    v_xad_u32 v217, v229, v234, v232
    v_xor_b32 v218, 64, v217
    v_add_u32 v40, 135168, v233
    v_xor_b32 v41, 64, v40
    v_xor_b32 v232, 16, v40
    v_add_u32 v42, 6144, v232
    v_xor_b32 v43, 64, v42
    v_lshrrev_b32 v228, 1, v3
    v_lshlrev_b32 v228, 4, v228
    v_xor_b32 v231, v231, v228
    v_and_b32 v229, 1, v3
    v_lshl_add_u32 v230, v229, 3, v230
    s_mul_i32 s64, s3, 96
    s_add_u32 s65, s64, 0
    v_xad_u32 v232, s65, v231, v230
    v_add_u32 v219, 122880, v232
    v_add_u32 v34, 135168, v232
    v_xor_b32 v232, 16, v232
    v_add_u32 v220, 129024, v232
    v_add_u32 v35, 141312, v232
    s_add_u32 s65, s64, 32
    v_xad_u32 v232, s65, v231, v230
    v_add_u32 v221, 122880, v232
    v_add_u32 v36, 135168, v232
    v_xor_b32 v232, 16, v232
    v_add_u32 v222, 129024, v232
    v_add_u32 v37, 141312, v232
    s_add_u32 s65, s64, 64
    v_xad_u32 v232, s65, v231, v230
    v_add_u32 v223, 122880, v232
    v_add_u32 v38, 135168, v232
    v_xor_b32 v232, 16, v232
    v_add_u32 v224, 129024, v232
    v_add_u32 v39, 141312, v232
    v_lshrrev_b32_e64 v228, 2, v2
    v_lshl_add_u32 v230, v3, 3, v228
    v_lshl_add_u32 v231, v229, 2, v228
    v_lshlrev_b32 v231, 5, v231
    v_and_b32 v232, 3, v2
    v_lshlrev_b32 v232, 3, v232
    v_mul_u32_u24 v233, 768, v230
    v_add_u32 v233, v233, v232
    s_add_u32 s65, s64, 0
    v_xad_u32 v202, s65, v231, v233
    v_add_u32 v22, 73728, v202
    s_add_u32 s65, s64, 32
    v_xad_u32 v203, s65, v231, v233
    v_add_u32 v23, 73728, v203
    s_add_u32 s65, s64, 64
    v_xad_u32 v204, s65, v231, v233
    v_add_u32 v24, 73728, v204
    s_add_u32 s65, s64, 384
    v_xad_u32 v205, s65, v231, v233
    v_add_u32 v25, 73728, v205
    s_add_u32 s65, s64, 416
    v_xad_u32 v206, s65, v231, v233
    v_add_u32 v26, 73728, v206
    s_add_u32 s65, s64, 448
    v_xad_u32 v207, s65, v231, v233
    v_add_u32 v27, 73728, v207
    v_lshrrev_b32 v228, 3, v2
    v_lshl_add_u32 v231, v229, 1, v228
    v_lshlrev_b32 v231, 5, v231
    v_mul_u32_u24 v233, 384, v230
    v_add_u32 v233, v233, v232
    s_add_u32 s65, s64, 0
    v_xad_u32 v208, s65, v231, v233
    v_add_u32 v240, 73728, v208
    s_add_u32 s65, s64, 32
    v_xad_u32 v209, s65, v231, v233
    v_add_u32 v241, 73728, v209
    s_add_u32 s65, s64, 64
    v_xad_u32 v210, s65, v231, v233
    v_add_u32 v242, 73728, v210
    v_lshrrev_b32 v230, 1, v3
    v_cmp_eq_u32 s[58:59], v228, v230
    v_cmp_eq_u32 s[60:61], 0, v229
    s_lshl_b32 s65, s3, 10
    s_add_u32 s65, s65, 147456
    v_add_u32 v225, s65, v32
    v_add_u32 v226, 147456, v32
    s_and_b32 s65, s3, 1
    s_lshl_b32 s65, s65, 2
    s_add_u32 s66, s38, 768
    v_add_u32_e64 v228, 0, v1
    v_mul_u32_u24 v228, 683, v228
    v_lshrrev_b32 v228, 14, v228
    v_and_b32 v229, 2, v228
    v_xor_b32 v229, s65, v229
    v_xor_b32 v229, v1, v229
    v_lshl_add_u32 v199, v229, 4, s63
    v_mul_u32_u24 v228, 768, v228
    v_lshl_add_u32 v228, v229, 4, v228
    v_add_u32 v196, s66, v228
    v_add_u32 v228, 64, v1
    v_mul_u32_u24 v228, 683, v228
    v_lshrrev_b32 v228, 14, v228
    v_and_b32 v229, 2, v228
    v_xor_b32 v229, s65, v229
    v_xor_b32 v229, v1, v229
    v_lshl_add_u32 v200, v229, 4, s63
    v_mul_u32_u24 v228, 768, v228
    v_lshl_add_u32 v228, v229, 4, v228
    v_add_u32 v197, s66, v228
    v_add_u32 v228, 128, v1
    v_mul_u32_u24 v228, 683, v228
    v_lshrrev_b32 v228, 14, v228
    v_and_b32 v229, 2, v228
    v_xor_b32 v229, s65, v229
    v_xor_b32_e64 v229, v1, v229
    v_lshl_add_u32 v201, v229, 4, s63
    v_mul_u32_u24 v228, 768, v228
    v_lshl_add_u32 v228, v229, 4, v228
    v_add_u32 v198, s66, v228
    v_mov_b64 v[166:167], 0
    v_mov_b64 v[182:183], 0
    v_mov_b64 v[174:175], 0
    v_mov_b64 v[190:191], 0
    s_mov_b64 exec, 0
    s_cmp_lg_u32 s3, 0
    s_cbranch_scc1 L_nv_1
    s_branch L_page0
L_pageret0:
L_nv_1:
    s_cmp_lg_u32 s3, 1
    s_cbranch_scc1 L_nv_2
    s_branch L_page1
L_pageret1:
L_nv_2:
    s_cmp_lg_u32 s3, 2
    s_cbranch_scc1 L_nv_3
    s_branch L_page2
L_pageret2:
L_nv_3:
    s_cmp_lg_u32 s3, 3
    s_cbranch_scc1 L_nv_4
    s_branch L_page3
L_pageret3:
L_nv_4:
    s_mov_b64 exec, -1
    v_and_b32 v235, 7, v2
    v_lshlrev_b32 v235, 2, v235
    v_lshrrev_b32 v236, 3, v2
    v_add_u32 v235, v235, v236
    v_lshrrev_b32 v236, 3, v235
    v_xor_b32 v236, v236, v235
    v_and_b32 v236, 14, v236
    v_lshlrev_b32 v237, 3, v236
    v_lshrrev_b32 v236, 1, v3
    v_lshlrev_b32 v236, 4, v236
    v_xor_b32 v237, v237, v236
    v_mul_u32_u24 v235, 384, v235
    v_and_b32_e64 v236, 1, v3
    v_lshl_add_u32 v235, v236, 3, v235
    v_add_u32 v235, 135168, v235
    s_mul_i32 s70, s3, 96
    s_add_u32 s71, s70, 0
    v_xad_u32 v243, s71, v237, v235
    v_xor_b32 v236, 16, v243
    v_add_u32 v244, 768, v236
    s_add_u32 s71, s70, 32
    v_xad_u32 v245, s71, v237, v235
    v_xor_b32_e64 v236, 16, v245
    v_add_u32 v246, 768, v236
    s_add_u32 s71, s70, 64
    v_xad_u32 v247, s71, v237, v235
    v_xor_b32 v236, 16, v247
    v_add_u32 v248, 768, v236
    s_lshl_b32 s70, s3, 2
    s_add_u32 s70, s70, 151552
    v_add_u32 v153, s70, v32
    v_lshlrev_b32 v235, 4, v2
    v_add_u32 v154, 151552, v235
    v_lshrrev_b32 v235, 2, v2
    v_and_b32 v236, 1, v3
    v_lshl_add_u32 v235, v236, 2, v235
    s_mov_b32 s70, 282624
    v_mul_lo_u32 v236, v235, s70
    v_cmp_gt_u32 s[76:77], 7, v235
    s_bfe_u32 s70, s2, 0x10001
    v_lshrrev_b32 v237, 1, v3
    v_xor_b32 v237, s70, v237
    v_lshl_add_u32 v236, v237, 6, v236
    v_and_b32_e64 v237, 3, v2
    v_lshl_add_u32 v236, v237, 4, v236
    v_mov_b32 v237, 2147418112
    v_cndmask_b32 v152, v237, v236, s[76:77]
    v_cmp_gt_u32 s[76:77], 32, v0
    s_lshl_b32 s70, s2, 8
    s_add_u32 s70, s70, 1978368
    v_lshl_add_u32 v236, v1, 3, s70
    v_cndmask_b32 v155, v237, v236, s[76:77]
    s_lshr_b32 s70, s2, 3
    s_mul_i32 s70, s70, 12288
    s_add_u32 s70, s70, s63
    s_and_b32 s71, s2, 7
    s_and_b32 s79, s3, 1
    s_xor_b32 s71, s71, s79
    s_lshl_b32 s71, s71, 7
    s_xor_b32 s79, s71, 128
    s_add_u32 s72, s71, s70
    s_add_u32 s73, s79, s70
    v_cmp_eq_u32 vcc, 0, v0
    v_mov_b32 v238, 2147418112
    s_nop 0
    v_cndmask_b32 v157, v238, v0, vcc
    s_mov_b64 s[74:75], vcc
    s_and_b32 s64, s2, 7
    s_mul_i32 s65, s64, 282624
    s_lshr_b32 s66, s2, 3
    s_add_u32 s67, s66, s3
    s_mul_i32 s52, s3, 36864
    s_mul_i32 s68, s66, 12288
    s_add_u32 s68, s68, s65
    s_add_u32 s47, s68, s63
    s_lshl_b32 s68, s66, 11
    s_lshl_b32 s69, s64, 5
    s_add_u32 s68, s68, s69
    s_add_u32 s50, s68, 1978368
    s_mul_i32 s68, s64, 3072
    s_add_u32 s51, s68, 2172928
    s_add_u32 s46, s65, 270336
    s_cmp_eq_u32 s66, 22
    s_cselect_b32 s38, 135168, 0
    s_cselect_b32 s68, 1, 0
    s_or_b32 s39, s68, s3
    s_cmp_ge_u32 s67, 22
    s_cselect_b32 s68, 22, 0
    s_sub_u32 s67, s67, s68
    s_mul_i32 s68, s67, 12288
    s_waitcnt vmcnt(8)
    s_add_u32 m0, s62, 24576
    s_mov_b32 s53, 36864
    buffer_load_dwordx4 v193, s[8:11], s53 offen offset:0 lds
    buffer_load_dwordx4 v194, s[8:11], s53 offen offset:1024 lds
    ds_write_b128 v212, v[4:7] offset:0
    ds_write_b128 v212, v[8:11] offset:128
    ds_write_b128 v212, v[12:15] offset:256
    s_mov_b32 s32, 0x3dd53b95
    s_mov_b32 s34, 0x3727c5ac
    v_mov_b32 v20, 0x3f803f80
    v_dot2_f32_bf16 v16, v4, v20, 0
    v_dot2_f32_bf16 v17, v4, v4, 0
    v_dot2_f32_bf16 v16, v5, v20, v16
    v_dot2_f32_bf16 v17, v5, v5, v17
    v_dot2_f32_bf16 v16, v6, v20, v16
    v_dot2_f32_bf16 v17, v6, v6, v17
    v_dot2_f32_bf16 v16, v7, v20, v16
    v_dot2_f32_bf16 v17, v7, v7, v17
    v_dot2_f32_bf16 v16, v8, v20, v16
    v_dot2_f32_bf16 v17, v8, v8, v17
    v_dot2_f32_bf16 v16, v9, v20, v16
    v_dot2_f32_bf16 v17, v9, v9, v17
    v_dot2_f32_bf16 v16, v10, v20, v16
    v_dot2_f32_bf16 v17, v10, v10, v17
    v_dot2_f32_bf16 v16, v11, v20, v16
    v_dot2_f32_bf16 v17, v11, v11, v17
    v_dot2_f32_bf16 v16, v12, v20, v16
    v_dot2_f32_bf16 v17, v12, v12, v17
    v_dot2_f32_bf16 v16, v13, v20, v16
    v_dot2_f32_bf16 v17, v13, v13, v17
    v_dot2_f32_bf16 v16, v14, v20, v16
    v_dot2_f32_bf16 v17, v14, v14, v17
    v_dot2_f32_bf16 v16, v15, v20, v16
    v_dot2_f32_bf16 v17, v15, v15, v17
    v_lshlrev_b32_e64 v64, 16, v4
    v_and_b32 v65, 0xffff0000, v4
    v_add_f32_dpp v16, v16, v16 quad_perm:[1,0,3,2] row_mask:0xf bank_mask:0xf
    v_add_f32_dpp v17, v17, v17 quad_perm:[1,0,3,2] row_mask:0xf bank_mask:0xf
    v_lshlrev_b32_e64 v66, 16, v5
    v_add_f32_dpp v16, v16, v16 quad_perm:[2,3,0,1] row_mask:0xf bank_mask:0xf
    v_add_f32_dpp v17, v17, v17 quad_perm:[2,3,0,1] row_mask:0xf bank_mask:0xf
    v_and_b32 v67, 0xffff0000, v5
    v_add_f32_dpp v16, v16, v16 row_half_mirror row_mask:0xf bank_mask:0xf
    v_add_f32_dpp v17, v17, v17 row_half_mirror row_mask:0xf bank_mask:0xf
    v_mul_f32 v16, 0x3baaaaab, v16
    v_mul_f32 v17, 0x3baaaaab, v17
    v_fma_f32 v17, -v16, v16, v17
    v_max_f32_e64 v17, 0, v17
    v_add_f32 v17, 0x3727c5ac, v17
    v_rsq_f32 v18, v17
    v_lshlrev_b32 v68, 16, v6
    v_and_b32 v69, 0xffff0000, v6
    v_lshlrev_b32 v70, 16, v7
    v_mul_f32 v19, v16, v18
    v_and_b32 v71, 0xffff0000, v7
    v_lshlrev_b32 v72, 16, v8
    v_and_b32 v73, 0xffff0000, v8
    v_lshlrev_b32 v74, 16, v9
    v_and_b32 v75, 0xffff0000, v9
    v_lshlrev_b32 v76, 16, v10
    v_and_b32 v77, 0xffff0000, v10
    v_lshlrev_b32 v78, 16, v11
    v_and_b32 v79, 0xffff0000, v11
    v_lshlrev_b32_e64 v80, 16, v12
    v_and_b32 v81, 0xffff0000, v12
    v_lshlrev_b32 v82, 16, v13
    v_and_b32 v83, 0xffff0000, v13
    v_lshlrev_b32 v84, 16, v14
    v_and_b32 v85, 0xffff0000, v14
    v_lshlrev_b32_e64 v86, 16, v15
    v_and_b32 v87, 0xffff0000, v15
    v_pk_fma_f32 v[64:65], v[64:65], v[18:19], v[18:19] op_sel:[0,0,1] op_sel_hi:[1,0,1] neg_lo:[0,0,1] neg_hi:[0,0,1]
    v_pk_fma_f32 v[66:67], v[66:67], v[18:19], v[18:19] op_sel:[0,0,1] op_sel_hi:[1,0,1] neg_lo:[0,0,1] neg_hi:[0,0,1]
    v_pk_fma_f32 v[68:69], v[68:69], v[18:19], v[18:19] op_sel:[0,0,1] op_sel_hi:[1,0,1] neg_lo:[0,0,1] neg_hi:[0,0,1]
    v_pk_fma_f32 v[70:71], v[70:71], v[18:19], v[18:19] op_sel:[0,0,1] op_sel_hi:[1,0,1] neg_lo:[0,0,1] neg_hi:[0,0,1]
    v_pk_fma_f32 v[72:73], v[72:73], v[18:19], v[18:19] op_sel:[0,0,1] op_sel_hi:[1,0,1] neg_lo:[0,0,1] neg_hi:[0,0,1]
    v_pk_fma_f32 v[74:75], v[74:75], v[18:19], v[18:19] op_sel:[0,0,1] op_sel_hi:[1,0,1] neg_lo:[0,0,1] neg_hi:[0,0,1]
    v_pk_fma_f32 v[76:77], v[76:77], v[18:19], v[18:19] op_sel:[0,0,1] op_sel_hi:[1,0,1] neg_lo:[0,0,1] neg_hi:[0,0,1]
    v_pk_fma_f32 v[78:79], v[78:79], v[18:19], v[18:19] op_sel:[0,0,1] op_sel_hi:[1,0,1] neg_lo:[0,0,1] neg_hi:[0,0,1]
    v_pk_fma_f32 v[80:81], v[80:81], v[18:19], v[18:19] op_sel:[0,0,1] op_sel_hi:[1,0,1] neg_lo:[0,0,1] neg_hi:[0,0,1]
    v_pk_fma_f32 v[82:83], v[82:83], v[18:19], v[18:19] op_sel:[0,0,1] op_sel_hi:[1,0,1] neg_lo:[0,0,1] neg_hi:[0,0,1]
    v_pk_fma_f32 v[84:85], v[84:85], v[18:19], v[18:19] op_sel:[0,0,1] op_sel_hi:[1,0,1] neg_lo:[0,0,1] neg_hi:[0,0,1]
    v_pk_fma_f32 v[86:87], v[86:87], v[18:19], v[18:19] op_sel:[0,0,1] op_sel_hi:[1,0,1] neg_lo:[0,0,1] neg_hi:[0,0,1]
    v_cvt_pk_bf16_f32 v88, v64, v65
    v_cvt_pk_bf16_f32 v89, v66, v67
    v_cvt_pk_bf16_f32 v90, v68, v69
    v_cvt_pk_bf16_f32 v91, v70, v71
    v_cvt_pk_bf16_f32 v92, v72, v73
    v_cvt_pk_bf16_f32 v93, v74, v75
    v_cvt_pk_bf16_f32 v94, v76, v77
    v_cvt_pk_bf16_f32 v95, v78, v79
    v_cvt_pk_bf16_f32 v96, v80, v81
    v_cvt_pk_bf16_f32 v97, v82, v83
    v_cvt_pk_bf16_f32 v98, v84, v85
    v_cvt_pk_bf16_f32 v99, v86, v87
    v_mov_b32 v158, 0xff800000
    ds_write_b128 v211, v[88:91] offset:0
    ds_write_b128 v211, v[92:95] offset:128
    ds_write_b128 v211, v[96:99] offset:256
    buffer_load_dwordx4 v195, s[8:11], s53 offen offset:2048 lds
    s_add_u32 m0, s62, 27648
    s_mov_b32 s53, 41472
    buffer_load_dwordx4 v193, s[8:11], s53 offen offset:0 lds
    buffer_load_dwordx4 v194, s[8:11], s53 offen offset:1024 lds
    s_waitcnt lgkmcnt(0)
    s_waitcnt vmcnt(7)
    s_barrier
    ds_read_b64_tr_b16 a[72:73], v202 offset:0
    ds_read_b64_tr_b16 a[74:75], v202 offset:3072
    ds_read_b64_tr_b16 a[76:77], v203 offset:0
    ds_read_b64_tr_b16 a[78:79], v203 offset:3072
    ds_read_b64_tr_b16 a[80:81], v204 offset:0
    ds_read_b64_tr_b16 a[82:83], v204 offset:3072
    ds_read_b64_tr_b16 a[84:85], v205 offset:0
    ds_read_b64_tr_b16 a[86:87], v205 offset:3072
    buffer_load_dwordx4 v195, s[8:11], s53 offen offset:2048 lds
    s_add_u32 m0, s62, 49152
    s_mov_b32 s53, 73728
    ds_read_b64_tr_b16 a[88:89], v206 offset:0
    ds_read_b64_tr_b16 a[90:91], v206 offset:3072
    ds_read_b64_tr_b16 a[92:93], v207 offset:0
    ds_read_b64_tr_b16 a[94:95], v207 offset:3072
    ds_read_b128 a[0:3], v213 offset:0
    ds_read_b128 a[24:27], v215 offset:0
    ds_read_b128 a[48:51], v217 offset:0
    ds_read_b128 a[4:7], v214 offset:0
    ds_read_b128 a[28:31], v216 offset:0
    buffer_load_dwordx4 v193, s[8:11], s53 offen offset:0 lds
    ds_read_b128 a[52:55], v218 offset:0
    ds_read_b128 a[8:11], v213 offset:128
    ds_read_b128 a[32:35], v215 offset:128
    ds_read_b128 a[56:59], v217 offset:128
    buffer_load_dwordx4 v194, s[8:11], s53 offen offset:1024 lds
    s_waitcnt lgkmcnt(8)
    v_mfma_f32_16x16x32_bf16 v[64:67], a[72:75], a[0:3], 0
    ds_read_b128 a[12:15], v214 offset:128
    ds_read_b128 a[36:39], v216 offset:128
    v_mfma_f32_16x16x32_bf16 v[72:75], a[76:79], a[0:3], 0
    ds_read_b128 a[60:63], v218 offset:128
    s_waitcnt lgkmcnt(9)
    v_mfma_f32_16x16x32_bf16 v[68:71], a[72:75], a[24:27], 0
    ds_read_b128 a[16:19], v213 offset:256
    v_mfma_f32_16x16x32_bf16 v[76:79], a[76:79], a[24:27], 0
    buffer_load_dwordx4 v195, s[8:11], s53 offen offset:2048 lds
L_page0:
    s_cbranch_execz L_pageret0
    s_add_u32 m0, s62, 52224
    s_mov_b32 s53, 78336
    v_mfma_f32_16x16x32_bf16 v[80:83], a[80:83], a[0:3], 0
    ds_read_b128 a[40:43], v215 offset:256
    ds_read_b128 a[64:67], v217 offset:256
    v_mfma_f32_16x16x32_bf16 v[84:87], a[80:83], a[24:27], 0
    ds_read_b128 a[20:23], v214 offset:256
    v_mfma_f32_16x16x32_bf16 v[88:91], a[84:87], a[0:3], 0
    ds_read_b128 a[44:47], v216 offset:256
    buffer_load_dwordx4 v193, s[8:11], s53 offen offset:0 lds
    v_mfma_f32_16x16x32_bf16 v[92:95], a[84:87], a[48:51], 0
    ds_read_b128 a[68:71], v218 offset:256
    ds_read_b64 v[4:5], v219
    v_mfma_f32_16x16x32_bf16 v[96:99], a[88:91], a[0:3], 0
    ds_read_b64 v[6:7], v220
    v_mfma_f32_16x16x32_bf16 v[100:103], a[88:91], a[48:51], 0
    ds_read_b64 v[8:9], v221
    v_mfma_f32_16x16x32_bf16 v[104:107], a[92:95], a[0:3], 0
    buffer_load_dwordx4 v194, s[8:11], s53 offen offset:1024 lds
    v_mfma_f32_16x16x32_bf16 v[108:111], a[92:95], a[48:51], 0
    ds_read_b64 v[10:11], v222
    ds_read_b64 v[12:13], v223
    ds_read_b64 v[14:15], v224
    buffer_load_dwordx4 v195, s[8:11], s53 offen offset:2048 lds
    s_add_u32 m0, s62, 73728
    s_mov_b32 s53, 110592
    buffer_load_dwordx4 v193, s[8:11], s53 offen offset:0 lds
    buffer_load_dwordx4 v194, s[8:11], s53 offen offset:1024 lds
    buffer_load_dwordx4 v195, s[8:11], s53 offen offset:2048 lds
    s_add_u32 m0, s62, 76800
    s_mov_b32 s53, 115200
    s_waitcnt vmcnt(9)
    s_barrier
    ds_read_b64_tr_b16 a[96:97], v202 offset:24576
    ds_read_b64_tr_b16 a[98:99], v202 offset:27648
    ds_read_b64_tr_b16 a[100:101], v203 offset:24576
    ds_read_b64_tr_b16 a[102:103], v203 offset:27648
    ds_read_b64_tr_b16 a[104:105], v204 offset:24576
    ds_read_b64_tr_b16 a[106:107], v204 offset:27648
    buffer_load_dwordx4 v193, s[8:11], s53 offen offset:0 lds
    ds_read_b64_tr_b16 a[108:109], v205 offset:24576
    ds_read_b64_tr_b16 a[110:111], v205 offset:27648
    ds_read_b64_tr_b16 a[112:113], v206 offset:24576
    ds_read_b64_tr_b16 a[114:115], v206 offset:27648
    ds_read_b64_tr_b16 a[116:117], v207 offset:24576
    ds_read_b64_tr_b16 a[118:119], v207 offset:27648
    s_waitcnt lgkmcnt(10)
    v_mfma_f32_16x16x32_bf16 v[64:67], a[96:99], a[4:7], v[64:67]
    v_mfma_f32_16x16x32_bf16 v[68:71], a[96:99], a[28:31], v[68:71]
    buffer_load_dwordx4 v194, s[8:11], s53 offen offset:1024 lds
    s_waitcnt lgkmcnt(6)
    v_mfma_f32_16x16x32_bf16 v[72:75], a[100:103], a[4:7], v[72:75]
    v_mfma_f32_16x16x32_bf16 v[76:79], a[100:103], a[28:31], v[76:79]
    v_mfma_f32_16x16x32_bf16 v[80:83], a[104:107], a[4:7], v[80:83]
    v_mfma_f32_16x16x32_bf16 v[84:87], a[104:107], a[28:31], v[84:87]
    buffer_load_dwordx4 v195, s[8:11], s53 offen offset:2048 lds
    s_add_u32 m0, s63, 98304
    s_mov_b32 s53, 0
    s_waitcnt lgkmcnt(0)
    v_mfma_f32_16x16x32_bf16 v[88:91], a[108:111], a[4:7], v[88:91]
    v_mfma_f32_16x16x32_bf16 v[92:95], a[108:111], a[52:55], v[92:95]
    v_mfma_f32_16x16x32_bf16 v[96:99], a[112:115], a[4:7], v[96:99]
    buffer_load_dwordx4 v196, s[8:11], s53 offen offset:0 lds
    v_mfma_f32_16x16x32_bf16 v[100:103], a[112:115], a[52:55], v[100:103]
    v_mfma_f32_16x16x32_bf16 v[104:107], a[116:119], a[4:7], v[104:107]
    v_mfma_f32_16x16x32_bf16 v[108:111], a[116:119], a[52:55], v[108:111]
    buffer_load_dwordx4 v197, s[8:11], s53 offen offset:1024 lds
    buffer_load_dwordx4 v198, s[8:11], s53 offen offset:2048 lds
    s_add_u32 m0, s63, 110592
    s_mov_b32 s53, 36864
    s_waitcnt vmcnt(9)
    s_barrier
    ds_read_b64_tr_b16 a[120:121], v202 offset:49152
    ds_read_b64_tr_b16 a[122:123], v202 offset:52224
    ds_read_b64_tr_b16 a[124:125], v203 offset:49152
    ds_read_b64_tr_b16 a[126:127], v203 offset:52224
    ds_read_b64_tr_b16 a[128:129], v204 offset:49152
    ds_read_b64_tr_b16 a[130:131], v204 offset:52224
    buffer_load_dwordx4 v196, s[8:11], s53 offen offset:0 lds
    ds_read_b64_tr_b16 a[132:133], v205 offset:49152
    ds_read_b64_tr_b16 a[134:135], v205 offset:52224
    ds_read_b64_tr_b16 a[136:137], v206 offset:49152
    ds_read_b64_tr_b16 a[138:139], v206 offset:52224
    ds_read_b64_tr_b16 a[140:141], v207 offset:49152
    ds_read_b64_tr_b16 a[142:143], v207 offset:52224
    s_waitcnt lgkmcnt(10)
    v_mfma_f32_16x16x32_bf16 v[64:67], a[120:123], a[8:11], v[64:67]
    v_mfma_f32_16x16x32_bf16 v[68:71], a[120:123], a[32:35], v[68:71]
    buffer_load_dwordx4 v197, s[8:11], s53 offen offset:1024 lds
    s_waitcnt lgkmcnt(6)
    v_mfma_f32_16x16x32_bf16 v[72:75], a[124:127], a[8:11], v[72:75]
    v_mfma_f32_16x16x32_bf16 v[76:79], a[124:127], a[32:35], v[76:79]
    v_mfma_f32_16x16x32_bf16 v[80:83], a[128:131], a[8:11], v[80:83]
    v_mfma_f32_16x16x32_bf16 v[84:87], a[128:131], a[32:35], v[84:87]
    buffer_load_dwordx4 v198, s[8:11], s53 offen offset:2048 lds
    s_add_u32 m0, s62, 0
    s_mov_b32 s53, 147456
    s_waitcnt lgkmcnt(0)
    v_mfma_f32_16x16x32_bf16 v[88:91], a[132:135], a[8:11], v[88:91]
    v_mfma_f32_16x16x32_bf16 v[92:95], a[132:135], a[56:59], v[92:95]
    v_mfma_f32_16x16x32_bf16 v[96:99], a[136:139], a[8:11], v[96:99]
    buffer_load_dwordx4 v193, s[8:11], s53 offen offset:0 lds
    v_mfma_f32_16x16x32_bf16 v[100:103], a[136:139], a[56:59], v[100:103]
    v_mfma_f32_16x16x32_bf16 v[104:107], a[140:143], a[8:11], v[104:107]
    v_mfma_f32_16x16x32_bf16 v[108:111], a[140:143], a[56:59], v[108:111]
    buffer_load_dwordx4 v194, s[8:11], s53 offen offset:1024 lds
    buffer_load_dwordx4 v195, s[8:11], s53 offen offset:2048 lds
    s_add_u32 m0, s62, 3072
    s_mov_b32 s53, 152064
    s_waitcnt vmcnt(9)
    s_barrier
    ds_read_b64_tr_b16 a[144:145], v22 offset:0
    ds_read_b64_tr_b16 a[146:147], v22 offset:3072
    ds_read_b64_tr_b16 a[148:149], v23 offset:0
    ds_read_b64_tr_b16 a[150:151], v23 offset:3072
    ds_read_b64_tr_b16 a[152:153], v24 offset:0
    ds_read_b64_tr_b16 a[154:155], v24 offset:3072
    buffer_load_dwordx4 v193, s[8:11], s53 offen offset:0 lds
    ds_read_b64_tr_b16 a[156:157], v25 offset:0
    ds_read_b64_tr_b16 a[158:159], v25 offset:3072
    ds_read_b64_tr_b16 a[160:161], v26 offset:0
    ds_read_b64_tr_b16 a[162:163], v26 offset:3072
    ds_read_b64_tr_b16 a[164:165], v27 offset:0
    ds_read_b64_tr_b16 a[166:167], v27 offset:3072
    s_waitcnt lgkmcnt(10)
    v_mfma_f32_16x16x32_bf16 v[64:67], a[144:147], a[12:15], v[64:67]
    v_mfma_f32_16x16x32_bf16 v[68:71], a[144:147], a[36:39], v[68:71]
    buffer_load_dwordx4 v194, s[8:11], s53 offen offset:1024 lds
    s_waitcnt lgkmcnt(6)
    v_mfma_f32_16x16x32_bf16 v[72:75], a[148:151], a[12:15], v[72:75]
    v_mfma_f32_16x16x32_bf16 v[76:79], a[148:151], a[36:39], v[76:79]
    v_mfma_f32_16x16x32_bf16 v[80:83], a[152:155], a[12:15], v[80:83]
    v_mfma_f32_16x16x32_bf16 v[84:87], a[152:155], a[36:39], v[84:87]
    buffer_load_dwordx4 v195, s[8:11], s53 offen offset:2048 lds
    s_add_u32 m0, s63, 24576
    s_mov_b32 s53, 73728
    s_waitcnt lgkmcnt(0)
    v_mfma_f32_16x16x32_bf16 v[88:91], a[156:159], a[12:15], v[88:91]
    v_mfma_f32_16x16x32_bf16 v[92:95], a[156:159], a[60:63], v[92:95]
    v_mfma_f32_16x16x32_bf16 v[96:99], a[160:163], a[12:15], v[96:99]
    buffer_load_dwordx4 v196, s[8:11], s53 offen offset:0 lds
    v_mfma_f32_16x16x32_bf16 v[100:103], a[160:163], a[60:63], v[100:103]
    v_mfma_f32_16x16x32_bf16 v[104:107], a[164:167], a[12:15], v[104:107]
    v_mfma_f32_16x16x32_bf16 v[108:111], a[164:167], a[60:63], v[108:111]
    buffer_load_dwordx4 v197, s[8:11], s53 offen offset:1024 lds
    buffer_load_dwordx4 v198, s[8:11], s53 offen offset:2048 lds
    s_add_u32 m0, s63, 36864
    s_mov_b32 s53, 110592
    s_waitcnt vmcnt(9)
    s_barrier
    ds_read_b64_tr_b16 a[168:169], v240 offset:24576
    ds_read_b64_tr_b16 a[170:171], v240 offset:26112
    ds_read_b64_tr_b16 a[172:173], v241 offset:24576
    ds_read_b64_tr_b16 a[174:175], v241 offset:26112
    ds_read_b64_tr_b16 a[176:177], v242 offset:24576
    ds_read_b64_tr_b16 a[178:179], v242 offset:26112
    buffer_load_dwordx4 v196, s[8:11], s53 offen offset:0 lds
    ds_read_b64_tr_b16 a[180:181], v240 offset:36864
    ds_read_b64_tr_b16 a[182:183], v240 offset:38400
    ds_read_b64_tr_b16 a[184:185], v241 offset:36864
    ds_read_b64_tr_b16 a[186:187], v241 offset:38400
    ds_read_b64_tr_b16 a[188:189], v242 offset:36864
    ds_read_b64_tr_b16 a[190:191], v242 offset:38400
    s_waitcnt lgkmcnt(10)
    v_mfma_f32_16x16x32_bf16 v[112:115], a[0:3], a[168:171], 0
    v_mfma_f32_16x16x32_bf16 v[116:119], a[48:51], a[168:171], 0
    buffer_load_dwordx4 v197, s[8:11], s53 offen offset:1024 lds
    s_waitcnt lgkmcnt(6)
    v_mfma_f32_16x16x32_bf16 v[120:123], a[0:3], a[172:175], 0
    v_mfma_f32_16x16x32_bf16 v[124:127], a[48:51], a[172:175], 0
    v_mfma_f32_16x16x32_bf16 v[128:131], a[0:3], a[176:179], 0
    v_mfma_f32_16x16x32_bf16 v[132:135], a[48:51], a[176:179], 0
    buffer_load_dwordx4 v198, s[8:11], s53 offen offset:2048 lds
    s_add_u32 m0, s62, 49152
    s_mov_b32 s53, 184320
    s_waitcnt lgkmcnt(0)
    v_mfma_f32_16x16x32_bf16 v[112:115], a[4:7], a[180:183], v[112:115]
    v_mfma_f32_16x16x32_bf16 v[116:119], a[52:55], a[180:183], v[116:119]
    v_mfma_f32_16x16x32_bf16 v[120:123], a[4:7], a[184:187], v[120:123]
    buffer_load_dwordx4 v193, s[8:11], s53 offen offset:0 lds
    v_mfma_f32_16x16x32_bf16 v[124:127], a[52:55], a[184:187], v[124:127]
    v_mfma_f32_16x16x32_bf16 v[128:131], a[4:7], a[188:191], v[128:131]
    v_mfma_f32_16x16x32_bf16 v[132:135], a[52:55], a[188:191], v[132:135]
    buffer_load_dwordx4 v194, s[8:11], s53 offen offset:1024 lds
    buffer_load_dwordx4 v195, s[8:11], s53 offen offset:2048 lds
    s_add_u32 m0, s62, 52224
    s_mov_b32 s53, 188928
    s_waitcnt vmcnt(9)
    s_barrier
    ds_read_b64_tr_b16 a[192:193], v202 offset:0
    ds_read_b64_tr_b16 a[194:195], v202 offset:3072
    ds_read_b64_tr_b16 a[196:197], v203 offset:0
    ds_read_b64_tr_b16 a[198:199], v203 offset:3072
    ds_read_b64_tr_b16 a[200:201], v204 offset:0
    ds_read_b64_tr_b16 a[202:203], v204 offset:3072
    buffer_load_dwordx4 v193, s[8:11], s53 offen offset:0 lds
    ds_read_b64_tr_b16 a[204:205], v205 offset:0
    ds_read_b64_tr_b16 a[206:207], v205 offset:3072
    ds_read_b64_tr_b16 a[208:209], v206 offset:0
    ds_read_b64_tr_b16 a[210:211], v206 offset:3072
    ds_read_b64_tr_b16 a[212:213], v207 offset:0
    ds_read_b64_tr_b16 a[214:215], v207 offset:3072
    s_waitcnt lgkmcnt(10)
    v_mfma_f32_16x16x32_bf16 v[64:67], a[192:195], a[16:19], v[64:67]
    v_mfma_f32_16x16x32_bf16 v[68:71], a[192:195], a[40:43], v[68:71]
    buffer_load_dwordx4 v194, s[8:11], s53 offen offset:1024 lds
    s_waitcnt lgkmcnt(6)
    v_mfma_f32_16x16x32_bf16 v[72:75], a[196:199], a[16:19], v[72:75]
    v_mfma_f32_16x16x32_bf16 v[76:79], a[196:199], a[40:43], v[76:79]
    v_mfma_f32_16x16x32_bf16 v[80:83], a[200:203], a[16:19], v[80:83]
    v_mfma_f32_16x16x32_bf16 v[84:87], a[200:203], a[40:43], v[84:87]
    buffer_load_dwordx4 v195, s[8:11], s53 offen offset:2048 lds
    s_add_u32 m0, s63, 73728
    s_mov_b32 s53, 147456
    s_waitcnt lgkmcnt(0)
    v_mfma_f32_16x16x32_bf16 v[88:91], a[204:207], a[16:19], v[88:91]
    v_mfma_f32_16x16x32_bf16 v[92:95], a[204:207], a[64:67], v[92:95]
    v_mfma_f32_16x16x32_bf16 v[96:99], a[208:211], a[16:19], v[96:99]
    buffer_load_dwordx4 v196, s[8:11], s53 offen offset:0 lds
    v_mfma_f32_16x16x32_bf16 v[100:103], a[208:211], a[64:67], v[100:103]
    v_mfma_f32_16x16x32_bf16 v[104:107], a[212:215], a[16:19], v[104:107]
    v_mfma_f32_16x16x32_bf16 v[108:111], a[212:215], a[64:67], v[108:111]
    buffer_load_dwordx4 v197, s[8:11], s53 offen offset:1024 lds
    buffer_load_dwordx4 v198, s[8:11], s53 offen offset:2048 lds
    s_add_u32 m0, s63, 86016
    s_mov_b32 s53, 184320
    s_waitcnt vmcnt(9)
    s_barrier
    ds_read_b64_tr_b16 a[72:73], v208 offset:24576
    ds_read_b64_tr_b16 a[74:75], v208 offset:26112
    ds_read_b64_tr_b16 a[76:77], v209 offset:24576
    ds_read_b64_tr_b16 a[78:79], v209 offset:26112
    ds_read_b64_tr_b16 a[80:81], v210 offset:24576
    ds_read_b64_tr_b16 a[82:83], v210 offset:26112
    buffer_load_dwordx4 v196, s[8:11], s53 offen offset:0 lds
    ds_read_b64_tr_b16 a[84:85], v208 offset:36864
    ds_read_b64_tr_b16 a[86:87], v208 offset:38400
    ds_read_b64_tr_b16 a[88:89], v209 offset:36864
    ds_read_b64_tr_b16 a[90:91], v209 offset:38400
    ds_read_b64_tr_b16 a[92:93], v210 offset:36864
    ds_read_b64_tr_b16 a[94:95], v210 offset:38400
    s_waitcnt lgkmcnt(10)
    v_mfma_f32_16x16x32_bf16 v[112:115], a[8:11], a[72:75], v[112:115]
    v_mfma_f32_16x16x32_bf16 v[116:119], a[56:59], a[72:75], v[116:119]
    buffer_load_dwordx4 v197, s[8:11], s53 offen offset:1024 lds
    s_waitcnt lgkmcnt(6)
    v_mfma_f32_16x16x32_bf16 v[120:123], a[8:11], a[76:79], v[120:123]
    v_mfma_f32_16x16x32_bf16 v[124:127], a[56:59], a[76:79], v[124:127]
    v_mfma_f32_16x16x32_bf16 v[128:131], a[8:11], a[80:83], v[128:131]
    v_mfma_f32_16x16x32_bf16 v[132:135], a[56:59], a[80:83], v[132:135]
    buffer_load_dwordx4 v198, s[8:11], s53 offen offset:2048 lds
    s_add_u32 m0, s63, 98304
    s_mov_b32 s53, 0
    s_waitcnt lgkmcnt(0)
    v_mfma_f32_16x16x32_bf16 v[112:115], a[12:15], a[84:87], v[112:115]
    v_mfma_f32_16x16x32_bf16 v[116:119], a[60:63], a[84:87], v[116:119]
    v_mfma_f32_16x16x32_bf16 v[120:123], a[12:15], a[88:91], v[120:123]
    v_mfma_f32_16x16x32_bf16 v[124:127], a[60:63], a[88:91], v[124:127]
    v_mfma_f32_16x16x32_bf16 v[128:131], a[12:15], a[92:95], v[128:131]
    v_mfma_f32_16x16x32_bf16 v[132:135], a[60:63], a[92:95], v[132:135]
    buffer_load_dwordx4 v199, s[16:19], s53 offen offset:0 lds
    buffer_load_dwordx4 v200, s[16:19], s53 offen offset:1024 lds
    s_waitcnt vmcnt(8)
    s_barrier
    ds_read_b64_tr_b16 a[96:97], v202 offset:49152
    ds_read_b64_tr_b16 a[98:99], v202 offset:52224
    ds_read_b64_tr_b16 a[100:101], v203 offset:49152
    ds_read_b64_tr_b16 a[102:103], v203 offset:52224
    ds_read_b64_tr_b16 a[104:105], v204 offset:49152
    ds_read_b64_tr_b16 a[106:107], v204 offset:52224
    ds_read_b64_tr_b16 a[108:109], v205 offset:49152
    ds_read_b64_tr_b16 a[110:111], v205 offset:52224
    ds_read_b64_tr_b16 a[112:113], v206 offset:49152
    ds_read_b64_tr_b16 a[114:115], v206 offset:52224
    ds_read_b64_tr_b16 a[116:117], v207 offset:49152
    buffer_load_dwordx4 v201, s[16:19], s53 offen offset:2048 lds
    s_add_u32 m0, s63, 110592
    s_mov_b32 s53, 12288
    ds_read_b64_tr_b16 a[118:119], v207 offset:52224
    s_waitcnt lgkmcnt(10)
    v_mfma_f32_16x16x32_bf16 v[64:67], a[96:99], a[20:23], v[64:67]
    v_mfma_f32_16x16x32_bf16 v[68:71], a[96:99], a[44:47], v[68:71]
    s_waitcnt lgkmcnt(6)
    v_mfma_f32_16x16x32_bf16 v[72:75], a[100:103], a[20:23], v[72:75]
    buffer_load_dwordx4 v199, s[16:19], s53 offen offset:0 lds
    v_mfma_f32_16x16x32_bf16 v[76:79], a[100:103], a[44:47], v[76:79]
    v_mfma_f32_16x16x32_bf16 v[80:83], a[104:107], a[20:23], v[80:83]
    v_mfma_f32_16x16x32_bf16 v[84:87], a[104:107], a[44:47], v[84:87]
    s_waitcnt lgkmcnt(0)
    v_mfma_f32_16x16x32_bf16 v[88:91], a[108:111], a[20:23], v[88:91]
    buffer_load_dwordx4 v200, s[16:19], s53 offen offset:1024 lds
    v_mfma_f32_16x16x32_bf16 v[92:95], a[108:111], a[68:71], v[92:95]
    v_cvt_pk_bf16_f32 v160, v64, v65
    v_cvt_pk_bf16_f32 v161, v66, v67
    v_mfma_f32_16x16x32_bf16 v[96:99], a[112:115], a[20:23], v[96:99]
    v_cvt_pk_bf16_f32 v162, v72, v73
    v_cvt_pk_bf16_f32 v163, v74, v75
    v_mfma_f32_16x16x32_bf16 v[100:103], a[112:115], a[68:71], v[100:103]
    v_cvt_pk_bf16_f32 v176, v88, v89
    v_cvt_pk_bf16_f32 v177, v90, v91
    v_mfma_f32_16x16x32_bf16 v[104:107], a[116:119], a[20:23], v[104:107]
    buffer_load_dwordx4 v201, s[16:19], s53 offen offset:2048 lds
    s_add_u32 m0, s63, 0
    s_mov_b32 s53, 24576
    v_mfma_f32_16x16x32_bf16 v[108:111], a[116:119], a[68:71], v[108:111]
    v_cvt_pk_bf16_f32 v178, v96, v97
    v_cvt_pk_bf16_f32 v179, v98, v99
    v_cvt_pk_bf16_f32 v168, v68, v69
    v_cvt_pk_bf16_f32 v169, v70, v71
    v_mfma_f32_16x16x32_bf16 v[136:139], v[176:179], v[160:163], 0
    v_cvt_pk_bf16_f32 v170, v76, v77
    v_cvt_pk_bf16_f32 v171, v78, v79
    v_cvt_pk_bf16_f32 v184, v92, v93
    v_cvt_pk_bf16_f32 v185, v94, v95
    v_cvt_pk_bf16_f32 v186, v100, v101
    v_cvt_pk_bf16_f32 v187, v102, v103
    v_cvt_pk_bf16_f32 v164, v80, v81
    v_cvt_pk_bf16_f32 v165, v82, v83
    v_mfma_f32_16x16x32_bf16 v[140:143], v[184:187], v[168:171], 0
    buffer_load_dwordx4 v199, s[16:19], s53 offen offset:0 lds
    v_cvt_pk_bf16_f32 v180, v104, v105
    v_cvt_pk_bf16_f32 v181, v106, v107
    v_cvt_pk_bf16_f32 v172, v84, v85
    v_cvt_pk_bf16_f32 v173, v86, v87
    v_mfma_f32_16x16x32_bf16 v[136:139], v[180:183], v[164:167], v[136:139]
    v_cvt_pk_bf16_f32 v188, v108, v109
    v_cvt_pk_bf16_f32 v189, v110, v111
    v_lshlrev_b32 v64, 16, v4
    v_and_b32 v65, 0xffff0000, v4
    v_mfma_f32_16x16x32_bf16 v[140:143], v[188:191], v[172:175], v[140:143]
    v_lshlrev_b32_e64 v66, 16, v5
    v_and_b32 v67, 0xffff0000, v5
    v_lshlrev_b32 v68, 16, v6
    v_and_b32 v69, 0xffff0000, v6
    v_lshlrev_b32 v70, 16, v7
    v_and_b32 v71, 0xffff0000, v7
    v_lshlrev_b32_e64 v72, 16, v8
    v_and_b32 v73, 0xffff0000, v8
    v_cndmask_b32 v144, v140, v136, s[58:59]
    v_cndmask_b32 v145, v141, v137, s[58:59]
    v_cndmask_b32 v146, v142, v138, s[58:59]
    v_cndmask_b32 v147, v143, v139, s[58:59]
    ds_write_b128 v225, v[144:147]
    v_lshlrev_b32_e64 v74, 16, v9
    v_and_b32 v75, 0xffff0000, v9
    v_lshlrev_b32 v76, 16, v10
    v_and_b32 v77, 0xffff0000, v10
    v_lshlrev_b32 v78, 16, v11
    v_and_b32 v79, 0xffff0000, v11
    v_lshlrev_b32 v80, 16, v12
    v_and_b32 v81, 0xffff0000, v12
    v_lshlrev_b32 v82, 16, v13
    v_and_b32 v83, 0xffff0000, v13
    v_lshlrev_b32_e64 v84, 16, v14
    v_and_b32 v85, 0xffff0000, v14
    v_lshlrev_b32 v86, 16, v15
    v_and_b32 v87, 0xffff0000, v15
    buffer_load_dwordx4 v200, s[16:19], s53 offen offset:1024 lds
    s_waitcnt lgkmcnt(0)
    s_waitcnt vmcnt(8)
    s_barrier
    ds_read_b64_tr_b16 a[120:121], v240 offset:0
    ds_read_b64_tr_b16 a[122:123], v240 offset:1536
    ds_read_b64_tr_b16 a[124:125], v240 offset:12288
    ds_read_b64_tr_b16 a[126:127], v240 offset:13824
    ds_read_b64_tr_b16 a[128:129], v241 offset:0
    ds_read_b64_tr_b16 a[130:131], v241 offset:1536
    ds_read_b64_tr_b16 a[132:133], v241 offset:12288
    ds_read_b64_tr_b16 a[134:135], v241 offset:13824
    ds_read_b128 v[136:139], v226 offset:0
    ds_read_b128 v[140:143], v226 offset:1024
    ds_read_b128 v[144:147], v226 offset:2048
    buffer_load_dwordx4 v201, s[16:19], s53 offen offset:2048 lds
    s_add_u32 m0, s63, 12288
    s_mov_b32 s53, 36864
    ds_read_b128 v[148:151], v226 offset:3072
    s_waitcnt lgkmcnt(10)
    v_mfma_f32_16x16x32_bf16 v[112:115], a[16:19], a[120:123], v[112:115]
    ds_read_b64_tr_b16 a[136:137], v242 offset:0
    ds_read_b64_tr_b16 a[138:139], v242 offset:1536
    v_mfma_f32_16x16x32_bf16 v[116:119], a[64:67], a[120:123], v[116:119]
    ds_read_b64_tr_b16 a[140:141], v242 offset:12288
    s_waitcnt lgkmcnt(9)
    v_mfma_f32_16x16x32_bf16 v[112:115], a[20:23], a[124:127], v[112:115]
    ds_read_b64_tr_b16 a[142:143], v242 offset:13824
    buffer_load_dwordx4 v199, s[16:19], s53 offen offset:0 lds
    v_mfma_f32_16x16x32_bf16 v[116:119], a[68:71], a[124:127], v[116:119]
    v_mfma_f32_16x16x32_bf16 v[120:123], a[16:19], a[128:131], v[120:123]
    v_mfma_f32_16x16x32_bf16 v[124:127], a[64:67], a[128:131], v[124:127]
    s_waitcnt lgkmcnt(5)
    v_mfma_f32_16x16x32_bf16 v[120:123], a[20:23], a[132:135], v[120:123]
    buffer_load_dwordx4 v200, s[16:19], s53 offen offset:1024 lds
    v_mfma_f32_16x16x32_bf16 v[124:127], a[68:71], a[132:135], v[124:127]
    v_add_f32 v136, v136, v140
    v_add_f32 v137, v137, v141
    v_add_f32 v138, v138, v142
    v_add_f32 v139, v139, v143
    s_waitcnt lgkmcnt(0)
    v_add_f32 v144, v144, v148
    v_add_f32 v145, v145, v149
    v_add_f32 v146, v146, v150
    v_add_f32 v147, v147, v151
    v_add_f32 v139, v139, v147
    v_add_f32 v136, v136, v144
    v_add_f32 v137, v137, v145
    v_add_f32 v138, v138, v146
    v_cndmask_b32 v139, v158, v139, s[60:61]
    v_max3_f32 v140, v136, v137, v138
    v_max_f32_e64 v140, v140, v139
    v_mfma_f32_16x16x32_bf16 v[128:131], a[16:19], a[136:139], v[128:131]
    buffer_load_dwordx4 v201, s[16:19], s53 offen offset:2048 lds
    s_add_u32 m0, s63, 24576
    s_mov_b32 s53, 49152
    v_mov_b32 v141, v140
    v_mfma_f32_16x16x32_bf16 v[132:135], a[64:67], a[136:139], v[132:135]
    v_cvt_pk_bf16_f32 v160, v112, v113
    v_permlane16_swap_b32 v141, v140
    v_max_f32 v140, v140, v141
    v_mul_f32 v140, s32, v140
    v_fma_f32 v136, v136, s32, -v140
    v_fma_f32 v137, v137, s32, -v140
    v_fma_f32 v138, v138, s32, -v140
    v_fma_f32 v139, v139, s32, -v140
    v_exp_f32 v136, v136
    v_exp_f32 v137, v137
    v_exp_f32 v138, v138
    v_exp_f32 v139, v139
    v_add_f32 v142, v136, v137
    v_add_f32 v141, v138, v139
    v_add_f32 v142, v142, v141
    v_mfma_f32_16x16x32_bf16 v[128:131], a[20:23], a[140:143], v[128:131]
    s_mov_b32 s32, 0x3baaaaab
    buffer_load_dwordx4 v199, s[16:19], s53 offen offset:0 lds
    v_mov_b32 v141, v142
    v_mfma_f32_16x16x32_bf16 v[132:135], a[68:71], a[140:143], v[132:135]
    v_cvt_pk_bf16_f32 v161, v114, v115
    v_permlane16_swap_b32 v141, v142
    v_add_f32 v142, v142, v141
    v_rcp_f32_e64 v142, v142
    v_cvt_pk_bf16_f32 v162, v116, v117
    v_mul_f32 v136, v136, v142
    v_mul_f32 v137, v137, v142
    v_mul_f32 v138, v138, v142
    v_mul_f32 v139, v139, v142
    v_cvt_pk_bf16_f32 v16, v136, v137
    v_cvt_pk_bf16_f32 v17, v138, v139
    v_cndmask_b32 v18, 0, v16, s[58:59]
    v_cndmask_b32 v19, 0, v17, s[58:59]
    v_cndmask_b32 v20, v16, 0, s[58:59]
    v_cndmask_b32 v21, v17, 0, s[58:59]
    v_mfma_f32_16x16x16_bf16 v[88:91], v[160:161], v[18:19], 0
    buffer_load_dwordx4 v200, s[16:19], s53 offen offset:1024 lds
    v_cvt_pk_bf16_f32 v163, v118, v119
    v_cvt_pk_bf16_f32 v164, v120, v121
    v_cvt_pk_bf16_f32 v165, v122, v123
    v_mfma_f32_16x16x16_bf16 v[92:95], v[162:163], v[20:21], 0
    v_cvt_pk_bf16_f32 v166, v124, v125
    v_cvt_pk_bf16_f32 v167, v126, v127
    v_mfma_f32_16x16x16_bf16 v[96:99], v[164:165], v[18:19], 0
    v_cvt_pk_bf16_f32 v168, v128, v129
    v_cvt_pk_bf16_f32 v169, v130, v131
    v_mfma_f32_16x16x16_bf16 v[100:103], v[166:167], v[20:21], 0
    s_nop 0
    v_mfma_f32_16x16x16_bf16 v[104:107], v[168:169], v[18:19], 0
    buffer_load_dwordx4 v201, s[16:19], s53 offen offset:2048 lds
    s_add_u32 m0, s63, 36864
    s_mov_b32 s53, 61440
    v_cvt_pk_bf16_f32 v170, v132, v133
    v_cvt_pk_bf16_f32 v171, v134, v135
    v_cvt_pk_bf16_f32 v176, v88, v89
    v_cvt_pk_bf16_f32 v177, v90, v91
    v_mfma_f32_16x16x16_bf16 v[108:111], v[170:171], v[20:21], 0
    ds_write_b64 v243, v[176:177]
    v_cvt_pk_bf16_f32 v178, v92, v93
    v_cvt_pk_bf16_f32 v179, v94, v95
    v_cvt_pk_bf16_f32 v180, v96, v97
    v_cvt_pk_bf16_f32 v181, v98, v99
    v_cvt_pk_bf16_f32 v182, v100, v101
    v_cvt_pk_bf16_f32 v183, v102, v103
    v_cvt_pk_bf16_f32 v184, v104, v105
    v_cvt_pk_bf16_f32 v185, v106, v107
    v_cvt_pk_bf16_f32 v186, v108, v109
    v_cvt_pk_bf16_f32 v187, v110, v111
    ds_write_b64 v244, v[178:179]
    ds_write_b64 v245, v[180:181]
    ds_write_b64 v246, v[182:183]
    ds_write_b64 v247, v[184:185]
    ds_write_b64 v248, v[186:187]
    buffer_load_dwordx4 v199, s[16:19], s53 offen offset:0 lds
    buffer_load_dwordx4 v200, s[16:19], s53 offen offset:1024 lds
    buffer_load_dwordx4 v201, s[16:19], s53 offen offset:2048 lds
    s_waitcnt lgkmcnt(0)
    s_waitcnt vmcnt(6)
    s_barrier
    ds_read_b128 a[0:3], v213 offset:0
    ds_read_b64_tr_b16 a[144:145], v240 offset:24576
    ds_read_b64_tr_b16 a[146:147], v240 offset:26112
    ds_read_b128 a[24:27], v215 offset:0
    ds_read_b64_tr_b16 a[148:149], v241 offset:24576
    ds_read_b64_tr_b16 a[150:151], v241 offset:26112
    ds_read_b64_tr_b16 a[152:153], v242 offset:24576
    ds_read_b64_tr_b16 a[154:155], v242 offset:26112
    ds_read_b128 a[4:7], v214 offset:0
    buffer_load_dword v156, v157, s[24:27], 0 offen sc1
    ds_read_b64_tr_b16 a[156:157], v240 offset:36864
    ds_read_b64_tr_b16 a[158:159], v240 offset:38400
    ds_read_b128 a[28:31], v216 offset:0
    ds_read_b64_tr_b16 a[160:161], v241 offset:36864
    s_waitcnt lgkmcnt(10)
    v_mfma_f32_16x16x32_bf16 v[64:67], a[144:147], a[0:3], v[64:67]
    ds_read_b64_tr_b16 a[162:163], v241 offset:38400
    s_waitcnt lgkmcnt(10)
    v_mfma_f32_16x16x32_bf16 v[68:71], a[144:147], a[24:27], v[68:71]
    ds_read_b64_tr_b16 a[164:165], v242 offset:36864
    s_waitcnt lgkmcnt(9)
    v_mfma_f32_16x16x32_bf16 v[72:75], a[148:151], a[0:3], v[72:75]
    ds_read_b64_tr_b16 a[166:167], v242 offset:38400
    ds_read_b128 a[8:11], v213 offset:128
    v_mfma_f32_16x16x32_bf16 v[76:79], a[148:151], a[24:27], v[76:79]
    ds_read_b64_tr_b16 a[168:169], v208 offset:0
    s_waitcnt lgkmcnt(9)
    v_mfma_f32_16x16x32_bf16 v[80:83], a[152:155], a[0:3], v[80:83]
    ds_read_b64_tr_b16 a[170:171], v208 offset:1536
    ds_read_b128 a[32:35], v215 offset:128
    v_mfma_f32_16x16x32_bf16 v[84:87], a[152:155], a[24:27], v[84:87]
    ds_read_b64_tr_b16 a[172:173], v209 offset:0
    s_waitcnt lgkmcnt(9)
    v_mfma_f32_16x16x32_bf16 v[64:67], a[156:159], a[4:7], v[64:67]
    ds_read_b64_tr_b16 a[174:175], v209 offset:1536
    ds_read_b64_tr_b16 a[176:177], v210 offset:0
    v_mfma_f32_16x16x32_bf16 v[68:71], a[156:159], a[28:31], v[68:71]
    ds_read_b64_tr_b16 a[178:179], v210 offset:1536
    s_waitcnt lgkmcnt(8)
    v_mfma_f32_16x16x32_bf16 v[72:75], a[160:163], a[4:7], v[72:75]
    ds_read_b128 a[12:15], v214 offset:128
    ds_read_b64_tr_b16 a[180:181], v208 offset:12288
    v_mfma_f32_16x16x32_bf16 v[76:79], a[160:163], a[28:31], v[76:79]
    ds_read_b64_tr_b16 a[182:183], v208 offset:13824
    ds_read_b128 a[36:39], v216 offset:128
    v_mfma_f32_16x16x32_bf16 v[80:83], a[164:167], a[4:7], v[80:83]
    ds_read_b64_tr_b16 a[184:185], v209 offset:12288
    ds_read_b64_tr_b16 a[186:187], v209 offset:13824
    v_mfma_f32_16x16x32_bf16 v[84:87], a[164:167], a[28:31], v[84:87]
    ds_read_b64_tr_b16 a[188:189], v210 offset:12288
    s_waitcnt lgkmcnt(9)
    v_mfma_f32_16x16x32_bf16 v[64:67], a[168:171], a[8:11], v[64:67]
    ds_read_b64_tr_b16 a[190:191], v210 offset:13824
    ds_read_b128 a[16:19], v213 offset:256
    v_mfma_f32_16x16x32_bf16 v[68:71], a[168:171], a[32:35], v[68:71]
    ds_read_b128 a[40:43], v215 offset:256
    ds_read_b128 a[20:23], v214 offset:256
    v_mfma_f32_16x16x32_bf16 v[72:75], a[172:175], a[8:11], v[72:75]
    ds_read_b128 a[44:47], v216 offset:256
    v_mfma_f32_16x16x32_bf16 v[76:79], a[172:175], a[32:35], v[76:79]
    s_waitcnt lgkmcnt(8)
    v_mfma_f32_16x16x32_bf16 v[80:83], a[176:179], a[8:11], v[80:83]
    v_mfma_f32_16x16x32_bf16 v[84:87], a[176:179], a[32:35], v[84:87]
    v_mfma_f32_16x16x32_bf16 v[64:67], a[180:183], a[12:15], v[64:67]
    v_mfma_f32_16x16x32_bf16 v[68:71], a[180:183], a[36:39], v[68:71]
L_page1:
    s_cbranch_execz L_pageret1
    s_waitcnt lgkmcnt(2)
    v_mfma_f32_16x16x32_bf16 v[72:75], a[184:187], a[12:15], v[72:75]
    v_mfma_f32_16x16x32_bf16 v[76:79], a[184:187], a[36:39], v[76:79]
    v_mfma_f32_16x16x32_bf16 v[80:83], a[188:191], a[12:15], v[80:83]
    v_mfma_f32_16x16x32_bf16 v[84:87], a[188:191], a[36:39], v[84:87]
    s_waitcnt vmcnt(1)
    s_barrier
    ds_read_b64_tr_b16 a[192:193], v208 offset:24576
    ds_read_b64_tr_b16 a[194:195], v208 offset:26112
    ds_read_b64_tr_b16 a[196:197], v208 offset:36864
    ds_read_b64_tr_b16 a[198:199], v208 offset:38400
    ds_read_b64_tr_b16 a[200:201], v209 offset:24576
    ds_read_b64_tr_b16 a[202:203], v209 offset:26112
    ds_read_b64_tr_b16 a[204:205], v209 offset:36864
    ds_read_b64_tr_b16 a[206:207], v209 offset:38400
    ds_read_b64_tr_b16 a[208:209], v210 offset:24576
    ds_read_b64_tr_b16 a[210:211], v210 offset:26112
    ds_read_b64_tr_b16 a[212:213], v210 offset:36864
    ds_read_b64_tr_b16 a[214:215], v210 offset:38400
    s_waitcnt lgkmcnt(10)
    v_mfma_f32_16x16x32_bf16 v[64:67], a[192:195], a[16:19], v[64:67]
    v_mfma_f32_16x16x32_bf16 v[68:71], a[192:195], a[40:43], v[68:71]
    s_waitcnt lgkmcnt(6)
    v_mfma_f32_16x16x32_bf16 v[64:67], a[196:199], a[20:23], v[64:67]
    v_mfma_f32_16x16x32_bf16 v[68:71], a[196:199], a[44:47], v[68:71]
    v_mfma_f32_16x16x32_bf16 v[72:75], a[200:203], a[16:19], v[72:75]
    v_mfma_f32_16x16x32_bf16 v[76:79], a[200:203], a[40:43], v[76:79]
    s_waitcnt lgkmcnt(0)
    v_mfma_f32_16x16x32_bf16 v[72:75], a[204:207], a[20:23], v[72:75]
    v_mfma_f32_16x16x32_bf16 v[76:79], a[204:207], a[44:47], v[76:79]
    v_mfma_f32_16x16x32_bf16 v[80:83], a[208:211], a[16:19], v[80:83]
    s_waitcnt vmcnt(0)
    v_cmp_gt_u32 s[76:77], 36, v156
    v_mfma_f32_16x16x32_bf16 v[84:87], a[208:211], a[40:43], v[84:87]
    s_and_b64 s[76:77], s[76:77], s[74:75]
    v_mfma_f32_16x16x32_bf16 v[80:83], a[212:215], a[20:23], v[80:83]
    v_mfma_f32_16x16x32_bf16 v[84:87], a[212:215], a[44:47], v[84:87]
    v_pk_mul_f32 v[92:93], v[64:65], v[64:65]
    v_pk_mul_f32 v[94:95], v[68:69], v[68:69]
    v_pk_add_f32 v[88:89], v[64:65], v[66:67]
    v_pk_fma_f32 v[92:93], v[66:67], v[66:67], v[92:93]
    v_pk_add_f32 v[90:91], v[68:69], v[70:71]
    v_pk_fma_f32 v[94:95], v[70:71], v[70:71], v[94:95]
    v_pk_add_f32 v[88:89], v[88:89], v[72:73]
    v_pk_fma_f32 v[92:93], v[72:73], v[72:73], v[92:93]
    v_pk_add_f32 v[90:91], v[90:91], v[76:77]
    v_pk_fma_f32 v[94:95], v[76:77], v[76:77], v[94:95]
    v_pk_add_f32 v[88:89], v[88:89], v[74:75]
    v_pk_fma_f32 v[92:93], v[74:75], v[74:75], v[92:93]
    v_pk_add_f32 v[90:91], v[90:91], v[78:79]
    v_pk_fma_f32 v[94:95], v[78:79], v[78:79], v[94:95]
    v_pk_add_f32 v[88:89], v[88:89], v[80:81]
    v_pk_fma_f32 v[92:93], v[80:81], v[80:81], v[92:93]
    v_pk_add_f32 v[90:91], v[90:91], v[84:85]
    v_pk_fma_f32 v[94:95], v[84:85], v[84:85], v[94:95]
    v_pk_add_f32 v[88:89], v[88:89], v[82:83]
    v_pk_fma_f32 v[92:93], v[82:83], v[82:83], v[92:93]
    v_pk_add_f32 v[90:91], v[90:91], v[86:87]
    v_pk_fma_f32 v[94:95], v[86:87], v[86:87], v[94:95]
    v_add_f32 v16, v88, v89
    v_add_f32 v18, v92, v93
    v_add_f32 v17, v90, v91
    v_add_f32 v19, v94, v95
    s_nop 0
    v_permlane16_swap_b32 v16, v17
    v_permlane16_swap_b32 v18, v19
    v_add_f32 v16, v16, v17
    v_add_f32 v18, v18, v19
    s_nop 1
    v_permlane32_swap_b32 v16, v18
    v_add_f32 v16, v16, v18
    ds_write_b32 v153, v16
    s_waitcnt lgkmcnt(0)
    s_cmp_lg_u64 s[76:77], 0
    s_cbranch_scc1 L_fcw
L_fcb:
    s_barrier
    ds_read_b128 v[136:139], v154 offset:0
    ds_read_b128 v[140:143], v154 offset:256
    ds_read_b128 v[144:147], v154 offset:512
    ds_read_b128 v[148:151], v154 offset:768
    s_waitcnt lgkmcnt(3)
    v_pk_add_f32 v[136:137], v[136:137], v[138:139]
    s_waitcnt lgkmcnt(2)
    v_pk_add_f32 v[140:141], v[140:141], v[142:143]
    s_waitcnt lgkmcnt(1)
    v_pk_add_f32 v[144:145], v[144:145], v[146:147]
    s_waitcnt lgkmcnt(0)
    v_pk_add_f32 v[148:149], v[148:149], v[150:151]
    v_add_f32 v16, v136, v137
    v_add_f32 v17, v140, v141
    v_add_f32 v18, v144, v145
    v_add_f32 v19, v148, v149
    v_pk_mul_f32 v[16:17], v[16:17], s[32:33] op_sel_hi:[1,0]
    v_pk_mul_f32 v[18:19], v[18:19], s[32:33] op_sel_hi:[1,0]
    v_pk_fma_f32 v[18:19], v[16:17], v[16:17], v[18:19] neg_lo:[1,0,0] neg_hi:[1,0,0]
    v_max_f32 v18, 0, v18
    v_max_f32 v19, 0, v19
    v_pk_add_f32 v[18:19], v[18:19], s[34:35] op_sel_hi:[1,0]
    v_rsq_f32 v20, v18
    v_rsq_f32_e64 v21, v19
    v_cndmask_b32 v24, v17, v16, s[60:61]
    v_pk_mul_f32 v[22:23], v[16:17], v[20:21]
    v_pk_fma_f32 v[64:65], v[64:65], v[20:21], v[22:23] op_sel:[0,0,0] op_sel_hi:[1,0,0] neg_lo:[0,0,1] neg_hi:[0,0,1]
    v_pk_fma_f32 v[66:67], v[66:67], v[20:21], v[22:23] op_sel:[0,0,0] op_sel_hi:[1,0,0] neg_lo:[0,0,1] neg_hi:[0,0,1]
    v_pk_fma_f32 v[68:69], v[68:69], v[20:21], v[22:23] op_sel:[0,1,1] op_sel_hi:[1,1,1] neg_lo:[0,0,1] neg_hi:[0,0,1]
    v_pk_fma_f32 v[70:71], v[70:71], v[20:21], v[22:23] op_sel:[0,1,1] op_sel_hi:[1,1,1] neg_lo:[0,0,1] neg_hi:[0,0,1]
    v_cvt_pk_bf16_f32 v88, v64, v65
    v_cvt_pk_bf16_f32 v89, v66, v67
    v_cvt_pk_bf16_f32 v90, v68, v69
    v_cvt_pk_bf16_f32 v91, v70, v71
    v_pk_fma_f32 v[72:73], v[72:73], v[20:21], v[22:23] op_sel:[0,0,0] op_sel_hi:[1,0,0] neg_lo:[0,0,1] neg_hi:[0,0,1]
    v_permlane16_swap_b32 v88, v90
    v_permlane16_swap_b32 v89, v91
    buffer_store_dwordx4 v[88:91], v152, s[12:15], s72 offen offset:0 sc1
    v_pk_fma_f32 v[74:75], v[74:75], v[20:21], v[22:23] op_sel:[0,0,0] op_sel_hi:[1,0,0] neg_lo:[0,0,1] neg_hi:[0,0,1]
    v_pk_fma_f32 v[76:77], v[76:77], v[20:21], v[22:23] op_sel:[0,1,1] op_sel_hi:[1,1,1] neg_lo:[0,0,1] neg_hi:[0,0,1]
    v_pk_fma_f32 v[78:79], v[78:79], v[20:21], v[22:23] op_sel:[0,1,1] op_sel_hi:[1,1,1] neg_lo:[0,0,1] neg_hi:[0,0,1]
    v_cvt_pk_bf16_f32 v92, v72, v73
    v_cvt_pk_bf16_f32 v93, v74, v75
    v_cvt_pk_bf16_f32 v94, v76, v77
    v_cvt_pk_bf16_f32 v95, v78, v79
    v_pk_fma_f32 v[80:81], v[80:81], v[20:21], v[22:23] op_sel:[0,0,0] op_sel_hi:[1,0,0] neg_lo:[0,0,1] neg_hi:[0,0,1]
    v_permlane16_swap_b32 v92, v94
    v_permlane16_swap_b32 v93, v95
    v_pk_fma_f32 v[82:83], v[82:83], v[20:21], v[22:23] op_sel:[0,0,0] op_sel_hi:[1,0,0] neg_lo:[0,0,1] neg_hi:[0,0,1]
    v_pk_fma_f32 v[84:85], v[84:85], v[20:21], v[22:23] op_sel:[0,1,1] op_sel_hi:[1,1,1] neg_lo:[0,0,1] neg_hi:[0,0,1]
    v_pk_fma_f32 v[86:87], v[86:87], v[20:21], v[22:23] op_sel:[0,1,1] op_sel_hi:[1,1,1] neg_lo:[0,0,1] neg_hi:[0,0,1]
    v_cvt_pk_bf16_f32 v96, v80, v81
    v_cvt_pk_bf16_f32 v97, v82, v83
    buffer_store_dwordx4 v[92:95], v152, s[12:15], s73 offen offset:1024 sc1
    v_cvt_pk_bf16_f32 v98, v84, v85
    v_cvt_pk_bf16_f32 v99, v86, v87
    v_pk_mul_f32 v[18:19], v[18:19], v[20:21]
    v_permlane16_swap_b32 v96, v98
    v_permlane16_swap_b32 v97, v99
    v_cndmask_b32 v25, v19, v18, s[60:61]
    buffer_store_dwordx4 v[96:99], v152, s[12:15], s72 offen offset:2048 sc1
    buffer_store_dwordx2 v[24:25], v155, s[12:15], 0 offen sc1
    s_mul_i32 s78, s3, 18432
    s_add_u32 s79, s78, 2025472
    buffer_load_dwordx4 a[112:115], v32, s[12:15], s79 offen offset:0 sc1
    buffer_load_dwordx4 a[116:119], v32, s[12:15], s79 offen offset:1024 sc1
    buffer_load_dwordx4 a[120:123], v32, s[12:15], s79 offen offset:2048 sc1
    s_mul_i32 s32, s2, 16
    s_add_u32 s32, s32, 2172928
    v_mul_u32_u24 v20, 3072, v0
    v_add_u32 v20, s32, v20
    v_cmp_gt_u32 vcc, 8, v0
    v_mov_b32 v21, 2147418112
    v_min_u32 v22, 45, v1
    v_cndmask_b32 v20, v21, v20, vcc
    v_mov_b32 v21, 1
    s_mul_i32 s32, s3, 46
    v_add_u32 v22, s32, v22
    v_mul_u32_u24 v22, 16, v22
    s_add_u32 s40, s68, s65
    s_add_u32 s67, s67, 4
    s_cmp_ge_u32 s67, 22
    s_cselect_b32 s68, 22, 0
    s_sub_u32 s67, s67, s68
    s_mul_i32 s68, s67, 12288
    s_add_u32 s41, s68, s65
    s_add_u32 s67, s67, 4
    s_cmp_ge_u32 s67, 22
    s_cselect_b32 s68, 22, 0
    s_sub_u32 s67, s67, s68
    s_mul_i32 s68, s67, 12288
    s_add_u32 s42, s68, s65
    s_add_u32 s67, s67, 4
    s_cmp_ge_u32 s67, 22
    s_cselect_b32 s68, 22, 0
    s_sub_u32 s67, s67, s68
    s_mul_i32 s68, s67, 12288
    s_add_u32 s43, s68, s65
    s_add_u32 s67, s67, 4
    s_cmp_ge_u32 s67, 22
    s_cselect_b32 s68, 22, 0
    s_sub_u32 s67, s67, s68
    s_mul_i32 s68, s67, 12288
    s_add_u32 s44, s68, s65
    s_add_u32 s67, s67, 4
    s_cmp_ge_u32 s67, 22
    s_cselect_b32 s68, 22, 0
    s_sub_u32 s67, s67, s68
    s_mul_i32 s68, s67, 12288
    s_add_u32 s45, s68, s65
    s_add_u32 s67, s67, 4
    s_cmp_ge_u32 s3, 2
    s_cselect_b32 s45, s46, s45
    s_cselect_b32 s49, 0xff800000, 0
    s_cmp_eq_u32 s3, 3
    s_cselect_b32 s48, 0xff800000, 0
    s_cselect_b32 s68, 2147418112, 0
    v_or_b32 v33, s68, v32
    s_add_u32 s68, s3, 0
    s_and_b32 s68, s68, 3
    s_mul_i32 s54, s68, 3072
    buffer_load_dwordx4 a[124:127], v32, s[12:15], s79 offen offset:3072 sc1
    s_add_u32 s79, s78, 2029568
    buffer_load_dwordx4 a[128:131], v32, s[12:15], s79 offen offset:0 sc1
    buffer_load_dwordx4 a[132:135], v32, s[12:15], s79 offen offset:1024 sc1
    s_add_u32 s68, s3, 1
    s_and_b32 s68, s68, 3
    s_mul_i32 s55, s68, 3072
    s_add_u32 s68, s3, 2
    s_and_b32 s68, s68, 3
    s_mul_i32 s56, s68, 3072
    s_add_u32 s68, s3, 3
    s_and_b32 s68, s68, 3
    s_mul_i32 s57, s68, 3072
    s_and_b32 s68, s3, 1
    s_lshl_b32 s68, s68, 7
    v_and_b32_e64 v228, 3, v1
    v_bfe_u32 v229, v1, 2, 3
    v_lshrrev_b32 v230, 5, v1
    v_bfe_u32 v231, v1, 3, 1
    v_xor_b32 v231, v231, v230
    v_lshlrev_b32_e64 v232, 4, v228
    v_lshl_add_u32 v232, v231, 6, v232
    v_lshl_add_u32 v232, v229, 7, v232
    v_xor_b32 v232, s68, v232
    v_add_u32 v28, s52, v232
    v_xor_b32 v29, 128, v28
    v_bfe_u32 v228, v1, 4, 1
    v_xor_b32 v229, v230, v228
    v_bfe_u32 v231, v1, 1, 1
    v_bfe_u32 v232, v1, 2, 2
    v_and_b32 v233, 1, v1
    v_lshlrev_b32_e64 v233, 3, v233
    v_lshl_add_u32 v233, v232, 4, v233
    v_lshl_add_u32 v233, v231, 6, v233
    v_lshl_add_u32 v233, v229, 7, v233
    v_lshl_add_u32 v233, v228, 10, v233
    v_xor_b32 v233, s68, v233
    v_add_u32 v30, s52, v233
    v_xor_b32 v31, 64, v30
    v_lshrrev_b32 v229, 2, v2
    v_lshrrev_b32 v231, 3, v2
    v_and_b32 v232, 3, v2
    v_lshlrev_b32 v233, 3, v232
    v_lshl_add_u32 v63, v229, 8, v233
    v_lshlrev_b32 v232, 4, v232
    v_xor_b32_e64 v233, v230, v231
    v_lshl_add_u32 v233, v233, 6, v232
    v_lshl_add_u32 v233, v228, 3, v233
    v_lshl_add_u32 v233, v229, 7, v233
    s_waitcnt vmcnt(6)
    s_waitcnt lgkmcnt(0)
    s_barrier
    buffer_store_dword v21, v20, s[12:15], 0 offen sc1
    s_and_b32 s32, s2, 7
    s_cmp_eq_u32 s32, 7
    s_cbranch_scc1 L_fin
    buffer_load_dwordx4 a[136:139], v32, s[12:15], s79 offen offset:2048 sc1
    buffer_load_dwordx4 a[140:143], v32, s[12:15], s79 offen offset:3072 sc1
    s_add_u32 s79, s78, 2033664
    buffer_load_dwordx4 a[144:147], v32, s[12:15], s79 offen offset:0 sc1
    v_xor_b32 v233, s68, v233
    s_add_u32 s69, s63, s38
    v_add_u32_e64 v61, s69, v233
    v_xor_b32 v62, 128, v61
    v_and_b32 v228, 31, v1
    v_lshrrev_b32 v231, 3, v228
    v_xor_b32 v231, v231, v228
    v_and_b32 v231, 14, v231
    v_lshlrev_b32_e64 v229, 3, v231
    v_mul_u32_u24 v228, 384, v228
    v_add_u32 v228, 147456, v228
    v_bfe_u32 v231, v1, 1, 2
    v_bfe_u32 v232, v1, 4, 1
    v_lshl_add_u32 v231, v232, 2, v231
    v_xor_b32 v231, v231, v230
    v_lshlrev_b32 v231, 4, v231
    s_lshr_b32 s68, s54, 5
    v_xad_u32 v240, s68, v231, v228
    s_add_u32 s68, s68, 32
    v_xad_u32 v241, s68, v231, v228
    s_add_u32 s68, s68, 32
    v_xad_u32 v242, s68, v231, v228
    s_lshr_b32 s68, s55, 5
    v_xad_u32 v243, s68, v231, v228
    s_add_u32 s68, s68, 32
    v_xad_u32 v244, s68, v231, v228
    s_add_u32 s68, s68, 32
    v_xad_u32 v245, s68, v231, v228
    s_lshr_b32 s68, s56, 5
    v_xad_u32 v246, s68, v231, v228
    s_add_u32 s68, s68, 32
    v_xad_u32 v247, s68, v231, v228
    buffer_load_dwordx4 a[148:151], v32, s[12:15], s79 offen offset:1024 sc1
    buffer_load_dwordx4 a[152:155], v32, s[12:15], s79 offen offset:2048 sc1
    buffer_load_dwordx4 a[156:159], v32, s[12:15], s79 offen offset:3072 sc1
    s_add_u32 s68, s68, 32
    v_xad_u32 v248, s68, v231, v228
    s_lshr_b32 s68, s57, 5
    v_xad_u32 v249, s68, v231, v228
    s_add_u32 s68, s68, 32
    v_xad_u32 v250, s68, v231, v228
    s_add_u32 s68, s68, 32
    v_xad_u32 v251, s68, v231, v228
    v_lshl_add_u32 v228, v230, 3, v228
    s_mul_i32 s69, s3, 96
    s_add_u32 s68, s69, 0
    v_xad_u32 v52, s68, v229, v228
    s_add_u32 s68, s69, 16
    v_xad_u32 v53, s68, v229, v228
    s_add_u32 s68, s69, 32
    v_xad_u32 v54, s68, v229, v228
    s_add_u32 s68, s69, 48
    v_xad_u32 v55, s68, v229, v228
    s_add_u32 s68, s69, 64
    v_xad_u32 v56, s68, v229, v228
    s_add_u32 s68, s69, 80
    v_xad_u32 v57, s68, v229, v228
    v_add_u32 v44, s52, v32
    v_lshlrev_b32 v228, 3, v1
    s_lshl_b32 s68, s3, 9
    s_add_u32 s68, s68, 159744
    v_add_u32 v48, s68, v228
    s_sub_u32 s68, s3, 1
    s_and_b32 s68, s68, 3
    s_mul_i32 s69, s68, 36864
    v_add_u32 v45, s69, v32
    s_lshl_b32 s68, s68, 9
    s_add_u32 s79, s78, 2037760
    buffer_load_dwordx4 a[160:163], v32, s[12:15], s79 offen offset:0 sc1
    buffer_load_dwordx4 a[164:167], v32, s[12:15], s79 offen offset:1024 sc1
    buffer_load_dwordx4 a[168:171], v32, s[12:15], s79 offen offset:2048 sc1
    s_add_u32 s68, s68, 159744
    v_add_u32 v49, s68, v228
    s_sub_u32 s68, s3, 2
    s_and_b32 s68, s68, 3
    s_mul_i32 s69, s68, 36864
    v_add_u32 v46, s69, v32
    s_lshl_b32 s68, s68, 9
    s_add_u32 s68, s68, 159744
    v_add_u32_e64 v50, s68, v228
    s_sub_u32 s68, s3, 3
    s_and_b32 s68, s68, 3
    s_mul_i32 s69, s68, 36864
    v_add_u32 v47, s69, v32
    s_lshl_b32 s68, s68, 9
    s_add_u32 s68, s68, 159744
    v_add_u32 v51, s68, v228
    v_lshrrev_b32 v228, 3, v1
    s_lshl_b32 s68, s66, 5
    s_lshl_b32 s69, s3, 3
    s_add_u32 s68, s68, s69
    v_add_u32_e64 v228, s68, v228
    v_mul_u32_u24 v229, 384, v228
    s_movk_i32 s69, 729
    v_cmp_gt_u32 s[76:77], s69, v228
    v_and_b32 v228, 7, v1
    v_lshl_add_u32 v229, v228, 4, v229
    s_mul_i32 s68, s64, 279936
    v_add_u32 v229, s68, v229
    v_mov_b32 v228, 2147418112
    v_cndmask_b32 v58, v228, v229, s[76:77]
    v_bfe_u32 v235, v2, 2, 1
    v_bfe_u32 v236, v2, 3, 1
    buffer_load_dwordx4 a[172:175], v32, s[12:15], s79 offen offset:3072 sc1
    s_add_u32 s79, s78, 2041856
    buffer_load_dwordx4 a[176:179], v32, s[12:15], s79 offen offset:0 sc1
    buffer_load_dwordx4 a[180:183], v32, s[12:15], s79 offen offset:1024 sc1
    v_xor_b32 v235, v235, v236
    v_lshl_add_u32 v237, v235, 2, v236
    v_lshrrev_b32 v238, 1, v3
    v_xor_b32 v239, v237, v238
    v_lshlrev_b32 v239, 7, v239
    v_lshl_add_u32 v239, v238, 10, v239
    v_and_b32 v238, 1, v3
    v_lshl_add_u32 v239, v238, 6, v239
    v_and_b32 v238, 3, v2
    v_lshl_add_u32 v239, v238, 4, v239
    v_add_u32 v60, s38, v239
    v_xor_b32 v239, 64, v60
    v_add_u32 v202, 256, v239
    v_lshl_add_u32 v237, v237, 2, v238
    v_bfe_u32 v238, v237, 1, 2
    v_lshl_add_u32 v238, v235, 2, v238
    v_lshrrev_b32 v235, 1, v3
    v_xor_b32 v238, v238, v235
    v_lshlrev_b32 v238, 4, v238
    v_mul_u32_u24 v237, 384, v237
    v_and_b32 v235, 1, v3
    v_lshl_add_u32 v237, v235, 3, v237
    v_add_u32 v237, 147456, v237
    s_mul_i32 s70, s3, 96
    s_add_u32 s71, s70, 0
    v_xad_u32 v196, s71, v238, v237
    s_add_u32 s71, s70, 32
    v_xad_u32 v197, s71, v238, v237
    s_add_u32 s71, s70, 64
    v_xad_u32 v198, s71, v238, v237
    s_mov_b32 s32, 0
L_poll_5:
    buffer_load_dword v21, v22, s[12:15], s51 offen sc1
    s_add_u32 s32, s32, 1
    s_waitcnt vmcnt(0)
    v_cmp_ne_u32 vcc, 1, v21
    s_cmp_gt_u32 s32, 262144
    s_cbranch_scc1 L_polld_6
    s_cbranch_vccnz L_poll_5
L_polld_6:
    s_barrier
    s_add_u32 m0, s63, s38
    s_nop 0
    buffer_load_dwordx4 v32, s[12:15], s47 offen offset:0 sc1 lds
    buffer_load_dwordx4 v32, s[12:15], s47 offen offset:1024 sc1 lds
    buffer_load_dwordx4 v32, s[12:15], s47 offen offset:2048 sc1 lds
    s_cmp_eq_u32 s39, 0
    s_cbranch_scc1 L_skip0_7
    s_add_u32 m0, s52, 0
    s_add_u32 s53, s40, s54
    buffer_load_dwordx4 v32, s[12:15], s53 offen offset:0 sc1 lds
    buffer_load_dwordx4 v32, s[12:15], s53 offen offset:1024 sc1 lds
    buffer_load_dwordx4 v32, s[12:15], s53 offen offset:2048 sc1 lds
    s_add_u32 m0, s52, 3072
    s_add_u32 s53, s40, s55
    buffer_load_dwordx4 v32, s[12:15], s53 offen offset:0 sc1 lds
    buffer_load_dwordx4 v32, s[12:15], s53 offen offset:1024 sc1 lds
    buffer_load_dwordx4 v32, s[12:15], s53 offen offset:2048 sc1 lds
    s_add_u32 m0, s52, 6144
    s_add_u32 s53, s40, s56
    buffer_load_dwordx4 v32, s[12:15], s53 offen offset:0 sc1 lds
    buffer_load_dwordx4 v32, s[12:15], s53 offen offset:1024 sc1 lds
    buffer_load_dwordx4 v32, s[12:15], s53 offen offset:2048 sc1 lds
    s_add_u32 m0, s52, 9216
    s_add_u32 s53, s40, s57
    buffer_load_dwordx4 v32, s[12:15], s53 offen offset:0 sc1 lds
    buffer_load_dwordx4 v32, s[12:15], s53 offen offset:1024 sc1 lds
    buffer_load_dwordx4 v32, s[12:15], s53 offen offset:2048 sc1 lds
    s_waitcnt vmcnt(12)
    s_branch L_join0_8
L_skip0_7:
    s_waitcnt vmcnt(0)
L_join0_8:
    s_barrier
    ds_read_b128 a[0:3], v60 offset:0
    ds_read_b128 a[24:27], v202 offset:0
    ds_read_b128 a[4:7], v60 offset:2048
    ds_read_b128 a[28:31], v202 offset:2048
    ds_read_b128 a[8:11], v60 offset:4096
    ds_read_b128 a[32:35], v202 offset:4096
    ds_read_b128 a[12:15], v60 offset:6144
    s_add_u32 m0, s52, 12288
    ds_read_b128 a[36:39], v202 offset:6144
    s_add_u32 s53, s41, s54
    ds_read_b128 a[16:19], v60 offset:8192
    s_waitcnt lgkmcnt(8)
    v_mfma_f32_16x16x32_bf16 v[64:67], a[112:115], a[0:3], 0
    ds_read_b128 a[40:43], v202 offset:8192
    s_waitcnt lgkmcnt(8)
    v_mfma_f32_16x16x32_bf16 v[68:71], a[112:115], a[24:27], 0
    ds_read_b128 a[20:23], v60 offset:10240
    s_waitcnt lgkmcnt(8)
    v_mfma_f32_16x16x32_bf16 v[64:67], a[116:119], a[4:7], v[64:67]
    ds_read_b128 a[44:47], v202 offset:10240
    s_waitcnt lgkmcnt(8)
    v_mfma_f32_16x16x32_bf16 v[68:71], a[116:119], a[28:31], v[68:71]
    ds_read_b64 v[208:209], v61 offset:0
    s_waitcnt lgkmcnt(8)
    v_mfma_f32_16x16x32_bf16 v[64:67], a[120:123], a[8:11], v[64:67]
    ds_read_b64 v[210:211], v61 offset:512
    s_waitcnt lgkmcnt(8)
    v_mfma_f32_16x16x32_bf16 v[68:71], a[120:123], a[32:35], v[68:71]
    ds_read_b64 v[212:213], v62 offset:1024
    s_waitcnt lgkmcnt(8)
    v_mfma_f32_16x16x32_bf16 v[64:67], a[124:127], a[12:15], v[64:67]
    ds_read_b64 v[214:215], v62 offset:1536
    s_waitcnt lgkmcnt(8)
    v_mfma_f32_16x16x32_bf16 v[68:71], a[124:127], a[36:39], v[68:71]
    ds_read_b64 v[216:217], v61 offset:2048
    s_waitcnt lgkmcnt(8)
    v_mfma_f32_16x16x32_bf16 v[64:67], a[128:131], a[16:19], v[64:67]
    ds_read_b64 v[218:219], v61 offset:2560
    s_waitcnt lgkmcnt(8)
    v_mfma_f32_16x16x32_bf16 v[68:71], a[128:131], a[40:43], v[68:71]
    s_waitcnt lgkmcnt(7)
    v_mfma_f32_16x16x32_bf16 v[64:67], a[132:135], a[20:23], v[64:67]
    s_waitcnt lgkmcnt(6)
    v_mfma_f32_16x16x32_bf16 v[68:71], a[132:135], a[44:47], v[68:71]
    s_waitcnt lgkmcnt(5)
    v_lshlrev_b32 v4, 16, v208
    v_mfma_f32_16x16x32_bf16 v[72:75], a[136:139], a[0:3], 0
    v_and_b32 v5, 0xffff0000, v208
    v_lshlrev_b32_e64 v6, 16, v209
    v_mfma_f32_16x16x32_bf16 v[76:79], a[136:139], a[24:27], 0
    v_cvt_pk_bf16_f32 v88, v64, v65
    v_cvt_pk_bf16_f32 v89, v66, v67
    v_mfma_f32_16x16x32_bf16 v[72:75], a[140:143], a[4:7], v[72:75]
    ds_write_b64 v196, v[88:89] offset:0
    v_cvt_pk_bf16_f32 v90, v68, v69
    v_mfma_f32_16x16x32_bf16 v[76:79], a[140:143], a[28:31], v[76:79]
    v_cvt_pk_bf16_f32 v91, v70, v71
    v_and_b32 v7, 0xffff0000, v209
    v_mfma_f32_16x16x32_bf16 v[72:75], a[144:147], a[8:11], v[72:75]
    ds_write_b64 v196, v[90:91] offset:3072
    v_mfma_f32_16x16x32_bf16 v[76:79], a[144:147], a[32:35], v[76:79]
    s_waitcnt lgkmcnt(2)
    v_lshlrev_b32 v8, 16, v210
    v_mfma_f32_16x16x32_bf16 v[72:75], a[148:151], a[12:15], v[72:75]
    v_and_b32 v9, 0xffff0000, v210
    v_lshlrev_b32 v10, 16, v211
    v_mfma_f32_16x16x32_bf16 v[76:79], a[148:151], a[36:39], v[76:79]
    v_and_b32 v11, 0xffff0000, v211
    v_lshlrev_b32 v12, 16, v212
    v_mfma_f32_16x16x32_bf16 v[72:75], a[152:155], a[16:19], v[72:75]
    v_and_b32 v13, 0xffff0000, v212
    v_lshlrev_b32_e64 v14, 16, v213
    v_mfma_f32_16x16x32_bf16 v[76:79], a[152:155], a[40:43], v[76:79]
    buffer_load_dwordx4 v32, s[12:15], s53 offen offset:0 sc1 lds
    v_mfma_f32_16x16x32_bf16 v[72:75], a[156:159], a[20:23], v[72:75]
    buffer_load_dwordx4 v32, s[12:15], s53 offen offset:1024 sc1 lds
    v_and_b32 v15, 0xffff0000, v213
    v_mfma_f32_16x16x32_bf16 v[76:79], a[156:159], a[44:47], v[76:79]
    v_lshlrev_b32 v16, 16, v214
    v_and_b32 v17, 0xffff0000, v214
    v_mfma_f32_16x16x32_bf16 v[80:83], a[160:163], a[0:3], 0
    v_lshlrev_b32 v18, 16, v215
    v_and_b32 v19, 0xffff0000, v215
    v_mfma_f32_16x16x32_bf16 v[84:87], a[160:163], a[24:27], 0
    v_cvt_pk_bf16_f32 v92, v72, v73
    v_cvt_pk_bf16_f32 v93, v74, v75
    v_mfma_f32_16x16x32_bf16 v[80:83], a[164:167], a[4:7], v[80:83]
    ds_write_b64 v197, v[92:93] offset:0
    v_cvt_pk_bf16_f32 v94, v76, v77
    v_mfma_f32_16x16x32_bf16 v[84:87], a[164:167], a[28:31], v[84:87]
    v_cvt_pk_bf16_f32 v95, v78, v79
    v_lshlrev_b32_e64 v20, 16, v216
    v_mfma_f32_16x16x32_bf16 v[80:83], a[168:171], a[8:11], v[80:83]
    ds_write_b64 v197, v[94:95] offset:3072
    v_and_b32 v21, 0xffff0000, v216
    v_mfma_f32_16x16x32_bf16 v[84:87], a[168:171], a[32:35], v[84:87]
    v_lshlrev_b32_e64 v22, 16, v217
    v_and_b32 v23, 0xffff0000, v217
    v_mfma_f32_16x16x32_bf16 v[80:83], a[172:175], a[12:15], v[80:83]
    v_lshlrev_b32 v24, 16, v218
    v_and_b32 v25, 0xffff0000, v218
    v_mfma_f32_16x16x32_bf16 v[84:87], a[172:175], a[36:39], v[84:87]
    v_lshlrev_b32 v26, 16, v219
    v_and_b32 v27, 0xffff0000, v219
    v_mfma_f32_16x16x32_bf16 v[80:83], a[176:179], a[16:19], v[80:83]
    v_mfma_f32_16x16x32_bf16 v[80:83], a[180:183], a[20:23], v[80:83]
    buffer_load_dwordx4 v32, s[12:15], s53 offen offset:2048 sc1 lds
    s_add_u32 m0, s52, 15360
    v_mfma_f32_16x16x32_bf16 v[84:87], a[176:179], a[40:43], v[84:87]
    s_add_u32 s53, s41, s55
    v_mfma_f32_16x16x32_bf16 v[84:87], a[180:183], a[44:47], v[84:87]
    buffer_load_dwordx4 v32, s[12:15], s53 offen offset:0 sc1 lds
    s_nop 1
    v_cvt_pk_bf16_f32 v96, v80, v81
    v_cvt_pk_bf16_f32 v97, v82, v83
    ds_write_b64 v198, v[96:97] offset:0
    s_nop 1
    v_cvt_pk_bf16_f32 v98, v84, v85
    v_cvt_pk_bf16_f32 v99, v86, v87
    ds_write_b64 v198, v[98:99] offset:3072
    buffer_load_dwordx4 v32, s[12:15], s53 offen offset:1024 sc1 lds
    s_waitcnt lgkmcnt(0)
    s_barrier
    buffer_load_dwordx4 v32, s[12:15], s53 offen offset:2048 sc1 lds
    s_waitcnt vmcnt(6)
    ds_read_b128 a[0:3], v240
    ds_read_b128 a[48:51], v28 offset:0
    ds_read_b128 a[4:7], v241
    ds_read_b128 a[52:55], v29 offset:1024
    ds_read_b128 a[8:11], v242
    ds_read_b128 a[56:59], v28 offset:2048
    ds_read_b128 a[12:15], v243
    s_waitcnt vmcnt(6)
    ds_read_b128 a[60:63], v29 offset:3072
    ds_read_b128 a[16:19], v244
    ds_read_b128 a[64:67], v28 offset:4096
    ds_read_b128 a[20:23], v245
    ds_read_b128 a[68:71], v29 offset:5120
    ds_read_b128 a[24:27], v246
    s_waitcnt vmcnt(6)
    ds_read_b128 a[72:75], v28 offset:6144
    s_waitcnt lgkmcnt(6)
    v_mfma_f32_32x32x16_bf16 v[160:175], a[48:51], a[0:3], 0
    ds_read_b128 a[28:31], v247
    ds_read_b128 a[76:79], v29 offset:7168
    s_add_u32 m0, s52, 18432
    s_add_u32 s53, s41, s56
    buffer_load_dwordx4 v32, s[12:15], s53 offen offset:0 sc1 lds
    v_mov_b32_e64 v234, 0
    v_mfma_f32_32x32x16_bf16 v[160:175], a[52:55], a[4:7], v[160:175]
    ds_read_b128 a[32:35], v248
    ds_read_b128 a[80:83], v28 offset:8192
    buffer_load_dwordx4 v32, s[12:15], s53 offen offset:1024 sc1 lds
    v_mov_b32 v239, 0x3e800000
    v_mov_b32 v236, 0x43800000
    v_mov_b32_e64 v192, 0
    v_mfma_f32_32x32x16_bf16 v[160:175], a[56:59], a[8:11], v[160:175]
    ds_read_b128 a[36:39], v249
    s_waitcnt vmcnt(8)
    ds_read_b128 a[84:87], v29 offset:9216
    buffer_load_dwordx4 v32, s[12:15], s53 offen offset:2048 sc1 lds
    v_mov_b32 v193, 0
    v_mov_b32_e64 v194, 0
    v_mfma_f32_32x32x16_bf16 v[160:175], a[60:63], a[12:15], v[160:175]
    ds_read_b128 a[40:43], v250
    ds_read_b128 a[48:51], v28 offset:10240
    s_add_u32 m0, s52, 21504
    s_add_u32 s53, s41, s57
    buffer_load_dwordx4 v32, s[12:15], s53 offen offset:0 sc1 lds
    s_waitcnt lgkmcnt(6)
    v_mfma_f32_32x32x16_bf16 v[160:175], a[64:67], a[16:19], v[160:175]
    ds_read_b128 a[44:47], v251
    ds_read_b128 a[52:55], v29 offset:11264
    buffer_load_dwordx4 v32, s[12:15], s53 offen offset:1024 sc1 lds
    v_mov_b32 v195, 0
    v_mov_b32 v196, 0
    v_mov_b32 v197, 0
    v_mfma_f32_32x32x16_bf16 v[160:175], a[68:71], a[20:23], v[160:175]
    s_waitcnt vmcnt(8)
    ds_read_b128 a[56:59], v28 offset:12288
    buffer_load_dwordx4 v32, s[12:15], s53 offen offset:2048 sc1 lds
    v_mov_b32 v198, 0
    v_mov_b32 v199, 0
    v_mov_b32_e64 v200, 0
    v_mfma_f32_32x32x16_bf16 v[160:175], a[72:75], a[24:27], v[160:175]
    ds_read_b128 a[60:63], v29 offset:13312
    s_add_u32 m0, s52, 24576
    s_add_u32 s53, s42, s54
    buffer_load_dwordx4 v32, s[12:15], s53 offen offset:0 sc1 lds
    v_mov_b32 v201, 0
    v_mov_b32 v202, 0
    v_mfma_f32_32x32x16_bf16 v[160:175], a[76:79], a[28:31], v[160:175]
    ds_read_b128 a[64:67], v28 offset:14336
    buffer_load_dwordx4 v32, s[12:15], s53 offen offset:1024 sc1 lds
    v_mov_b32 v203, 0
    v_mov_b32 v204, 0
    v_mov_b32 v205, 0
    s_waitcnt lgkmcnt(3)
    v_mfma_f32_32x32x16_bf16 v[160:175], a[80:83], a[32:35], v[160:175]
    s_waitcnt vmcnt(8)
    ds_read_b128 a[68:71], v29 offset:15360
L_page2:
    s_cbranch_execz L_pageret2
    v_mov_b32 v206, 0
    v_mov_b32_e64 v207, 0
    v_mfma_f32_32x32x16_bf16 v[160:175], a[84:87], a[36:39], v[160:175]
    ds_read_b128 a[72:75], v28 offset:16384
    buffer_load_dwordx4 v32, s[12:15], s53 offen offset:2048 sc1 lds
    v_mfma_f32_32x32x16_bf16 v[160:175], a[48:51], a[40:43], v[160:175]
    ds_read_b128 a[76:79], v29 offset:17408
    s_add_u32 m0, s52, 27648
    s_add_u32 s53, s42, s55
    v_mfma_f32_32x32x16_bf16 v[160:175], a[52:55], a[44:47], v[160:175]
    s_waitcnt vmcnt(6)
    ds_read_b128 a[80:83], v28 offset:18432
    buffer_load_dwordx4 v32, s[12:15], s53 offen offset:0 sc1 lds
    s_waitcnt lgkmcnt(3)
    v_mfma_f32_32x32x16_bf16 v[176:191], a[56:59], a[0:3], 0
    ds_read_b128 a[84:87], v29 offset:19456
    buffer_load_dwordx4 v32, s[12:15], s53 offen offset:1024 sc1 lds
    v_mfma_f32_32x32x16_bf16 v[176:191], a[60:63], a[4:7], v[176:191]
    ds_read_b128 a[48:51], v28 offset:20480
    s_nop 2
    v_exp_f32 v224, v160
    v_exp_f32 v225, v161
    v_exp_f32 v226, v162
    v_add_f32 v233, v224, v225
    v_cvt_pk_bf16_f32 v208, v224, v225
    v_mfma_f32_32x32x16_bf16 v[176:191], a[64:67], a[8:11], v[176:191]
    s_waitcnt vmcnt(5)
    ds_read_b128 a[52:55], v29 offset:21504
    buffer_load_dwordx4 v32, s[12:15], s53 offen offset:2048 sc1 lds
    v_exp_f32 v227, v163
    v_exp_f32 v228, v164
    v_add_f32 v233, v233, v226
    v_add_f32_e64 v233, v233, v227
    v_mfma_f32_32x32x16_bf16 v[176:191], a[68:71], a[12:15], v[176:191]
    ds_read_b128 a[56:59], v28 offset:22528
    s_add_u32 m0, s52, 30720
    s_add_u32 s53, s42, s56
    v_cvt_pk_bf16_f32 v209, v226, v227
    v_exp_f32 v229, v165
    v_exp_f32 v230, v166
    s_waitcnt lgkmcnt(3)
    v_mfma_f32_32x32x16_bf16 v[176:191], a[72:75], a[16:19], v[176:191]
    ds_read_b128 a[60:63], v29 offset:23552
    buffer_load_dwordx4 v32, s[12:15], s53 offen offset:0 sc1 lds
    v_add_f32 v233, v233, v228
    v_add_f32 v233, v233, v229
    v_cvt_pk_bf16_f32 v210, v228, v229
    v_exp_f32 v231, v167
    v_exp_f32 v224, v168
    v_mfma_f32_32x32x16_bf16 v[176:191], a[76:79], a[20:23], v[176:191]
    ds_read_b64_tr_b16 a[64:65], v30 offset:0
    ds_read_b64_tr_b16 a[66:67], v31 offset:256
    buffer_load_dwordx4 v32, s[12:15], s53 offen offset:1024 sc1 lds
    v_add_f32 v233, v233, v230
    v_add_f32 v233, v233, v231
    v_cvt_pk_bf16_f32 v211, v230, v231
    v_exp_f32_e64 v225, v169
    v_mfma_f32_32x32x16_bf16 v[176:191], a[80:83], a[24:27], v[176:191]
    ds_read_b64_tr_b16 a[68:69], v30 offset:512
    ds_read_b64_tr_b16 a[70:71], v31 offset:768
    v_exp_f32 v226, v170
    v_add_f32 v233, v233, v224
    v_add_f32 v233, v233, v225
    v_cvt_pk_bf16_f32 v212, v224, v225
    v_exp_f32 v227, v171
    v_mfma_f32_32x32x16_bf16 v[176:191], a[84:87], a[28:31], v[176:191]
    ds_read_b64_tr_b16 a[72:73], v30 offset:2048
    ds_read_b64_tr_b16 a[74:75], v31 offset:2304
    buffer_load_dwordx4 v32, s[12:15], s53 offen offset:2048 sc1 lds
    v_exp_f32 v228, v172
    v_add_f32 v233, v233, v226
    v_add_f32 v233, v233, v227
    v_cvt_pk_bf16_f32 v213, v226, v227
    s_waitcnt lgkmcnt(6)
    v_mfma_f32_32x32x16_bf16 v[176:191], a[48:51], a[32:35], v[176:191]
    ds_read_b64_tr_b16 a[76:77], v30 offset:2560
    ds_read_b64_tr_b16 a[78:79], v31 offset:2816
    s_add_u32 m0, s52, 33792
    s_add_u32 s53, s42, s57
    v_exp_f32 v229, v173
    v_exp_f32 v230, v174
    v_add_f32 v233, v233, v228
    v_mfma_f32_32x32x16_bf16 v[176:191], a[52:55], a[36:39], v[176:191]
    ds_read_b64_tr_b16 a[80:81], v30 offset:4096
    ds_read_b64_tr_b16 a[82:83], v31 offset:4352
    buffer_load_dwordx4 v32, s[12:15], s53 offen offset:0 sc1 lds
    v_add_f32 v233, v233, v229
    v_cvt_pk_bf16_f32 v214, v228, v229
    v_exp_f32 v231, v175
    v_add_f32 v233, v233, v230
    v_add_f32 v233, v233, v231
    v_mfma_f32_32x32x16_bf16 v[176:191], a[56:59], a[40:43], v[176:191]
    ds_read_b64_tr_b16 a[84:85], v30 offset:4608
    ds_read_b64_tr_b16 a[86:87], v31 offset:4864
    buffer_load_dwordx4 v32, s[12:15], s53 offen offset:1024 sc1 lds
    v_cvt_pk_bf16_f32 v215, v230, v231
    v_med3_f32 v235, v233, v236, v239
    v_cmp_neq_f32_e64 vcc, v233, v235
    v_mfma_f32_32x32x16_bf16 v[176:191], a[60:63], a[44:47], v[176:191]
    ds_read_b64_tr_b16 a[48:49], v30 offset:6144
    ds_read_b64_tr_b16 a[50:51], v31 offset:6400
    s_cbranch_vccnz L_resc_9
L_rescb_10:
    s_waitcnt lgkmcnt(6)
    v_mfma_f32_32x32x16_bf16 v[64:79], a[64:67], v[208:211], 0
    ds_read_b64_tr_b16 a[52:53], v30 offset:6656
    ds_read_b64_tr_b16 a[54:55], v31 offset:6912
    buffer_load_dwordx4 v32, s[12:15], s53 offen offset:2048 sc1 lds
    v_mov_b32_e64 v232, v233
    v_mfma_f32_32x32x16_bf16 v[64:79], a[68:71], v[212:215], v[64:79]
    ds_read_b64_tr_b16 a[56:57], v30 offset:8192
    ds_read_b64_tr_b16 a[58:59], v31 offset:8448
    s_add_u32 m0, s52, 0
    s_add_u32 s53, s43, s54
    v_exp_f32_e64 v224, v176
    v_mfma_f32_32x32x16_bf16 v[80:95], a[72:75], v[208:211], 0
    ds_read_b64_tr_b16 a[60:61], v30 offset:8704
    ds_read_b64_tr_b16 a[62:63], v31 offset:8960
    buffer_load_dwordx4 v32, s[12:15], s53 offen offset:0 sc1 lds
    v_exp_f32_e64 v225, v177
    v_mfma_f32_32x32x16_bf16 v[80:95], a[76:79], v[212:215], v[80:95]
    ds_read_b64_tr_b16 a[64:65], v30 offset:10240
    ds_read_b64_tr_b16 a[66:67], v31 offset:10496
    v_exp_f32 v226, v178
    v_add_f32_e64 v233, v224, v225
    s_waitcnt lgkmcnt(6)
    v_mfma_f32_32x32x16_bf16 v[96:111], a[80:83], v[208:211], 0
    ds_read_b64_tr_b16 a[68:69], v30 offset:10752
    ds_read_b64_tr_b16 a[70:71], v31 offset:11008
    buffer_load_dwordx4 v32, s[12:15], s53 offen offset:1024 sc1 lds
    v_cvt_pk_bf16_f32 v216, v224, v225
    v_exp_f32 v227, v179
    v_mfma_f32_32x32x16_bf16 v[96:111], a[84:87], v[212:215], v[96:111]
    s_waitcnt vmcnt(11)
    ds_read_b128 a[72:75], v28 offset:24576
    v_exp_f32 v228, v180
    v_add_f32 v233, v233, v226
    v_add_f32_e64 v233, v233, v227
    v_mfma_f32_32x32x16_bf16 v[112:127], a[48:51], v[208:211], 0
    ds_read_b128 a[76:79], v29 offset:25600
    buffer_load_dwordx4 v32, s[12:15], s53 offen offset:2048 sc1 lds
    v_cvt_pk_bf16_f32 v217, v226, v227
    v_exp_f32_e64 v229, v181
    v_mfma_f32_32x32x16_bf16 v[112:127], a[52:55], v[212:215], v[112:127]
    ds_read_b128 a[80:83], v28 offset:26624
    s_add_u32 m0, s52, 3072
    s_add_u32 s53, s43, s55
    v_exp_f32 v230, v182
    s_waitcnt lgkmcnt(3)
    v_mfma_f32_32x32x16_bf16 v[128:143], a[56:59], v[208:211], 0
    s_waitcnt vmcnt(9)
    ds_read_b128 a[84:87], v29 offset:27648
    buffer_load_dwordx4 v32, s[12:15], s53 offen offset:0 sc1 lds
    v_add_f32 v233, v233, v228
    v_add_f32 v233, v233, v229
    v_cvt_pk_bf16_f32 v218, v228, v229
    v_mfma_f32_32x32x16_bf16 v[128:143], a[60:63], v[212:215], v[128:143]
    ds_read_b128 a[48:51], v28 offset:28672
    v_exp_f32 v231, v183
    v_exp_f32 v224, v184
    v_add_f32_e64 v233, v233, v230
    v_mfma_f32_32x32x16_bf16 v[144:159], a[64:67], v[208:211], 0
    ds_read_b128 a[52:55], v29 offset:29696
    buffer_load_dwordx4 v32, s[12:15], s53 offen offset:1024 sc1 lds
    v_add_f32_e64 v233, v233, v231
    v_cvt_pk_bf16_f32 v219, v230, v231
    v_exp_f32 v225, v185
    v_mfma_f32_32x32x16_bf16 v[144:159], a[68:71], v[212:215], v[144:159]
    s_waitcnt vmcnt(8)
    ds_read_b128 a[56:59], v28 offset:30720
    v_exp_f32 v226, v186
    v_add_f32_e64 v233, v233, v224
    s_waitcnt lgkmcnt(3)
    v_mfma_f32_32x32x16_bf16 v[160:175], a[72:75], a[0:3], v[192:207]
    ds_read_b128 a[60:63], v29 offset:31744
    buffer_load_dwordx4 v32, s[12:15], s53 offen offset:2048 sc1 lds
    v_add_f32 v233, v233, v225
    v_cvt_pk_bf16_f32 v220, v224, v225
    v_exp_f32 v227, v187
    v_mfma_f32_32x32x16_bf16 v[160:175], a[76:79], a[4:7], v[160:175]
    ds_read_b128 a[64:67], v28 offset:32768
    s_add_u32 m0, s52, 6144
    s_add_u32 s53, s43, s56
    v_exp_f32 v228, v188
    v_add_f32_e64 v233, v233, v226
    v_mfma_f32_32x32x16_bf16 v[160:175], a[80:83], a[8:11], v[160:175]
    s_waitcnt vmcnt(6)
    ds_read_b128 a[68:71], v29 offset:33792
    buffer_load_dwordx4 v32, s[12:15], s53 offen offset:0 sc1 lds
    v_add_f32 v233, v233, v227
    v_cvt_pk_bf16_f32 v221, v226, v227
    v_mfma_f32_32x32x16_bf16 v[160:175], a[84:87], a[12:15], v[160:175]
    ds_read_b128 a[72:75], v28 offset:34816
    v_exp_f32 v229, v189
    v_exp_f32 v230, v190
    s_waitcnt lgkmcnt(3)
    v_mfma_f32_32x32x16_bf16 v[160:175], a[48:51], a[16:19], v[160:175]
    ds_read_b128 a[76:79], v29 offset:35840
    buffer_load_dwordx4 v32, s[12:15], s53 offen offset:1024 sc1 lds
    v_add_f32 v233, v233, v228
    v_add_f32_e64 v233, v233, v229
    v_cvt_pk_bf16_f32 v222, v228, v229
    v_mfma_f32_32x32x16_bf16 v[160:175], a[52:55], a[20:23], v[160:175]
    ds_read_b64_tr_b16 a[80:81], v30 offset:12288
    ds_read_b64_tr_b16 a[82:83], v31 offset:12544
    v_exp_f32 v231, v191
    v_add_f32 v233, v233, v230
    v_add_f32_e64 v233, v233, v231
    v_mfma_f32_32x32x16_bf16 v[160:175], a[56:59], a[24:27], v[160:175]
    ds_read_b64_tr_b16 a[84:85], v30 offset:12800
    ds_read_b64_tr_b16 a[86:87], v31 offset:13056
    buffer_load_dwordx4 v32, s[12:15], s53 offen offset:2048 sc1 lds
    v_cvt_pk_bf16_f32 v223, v230, v231
    v_cmp_nle_f32_e64 vcc, v233, v236
    v_mfma_f32_32x32x16_bf16 v[160:175], a[60:63], a[28:31], v[160:175]
    ds_read_b64_tr_b16 a[48:49], v30 offset:14336
    ds_read_b64_tr_b16 a[50:51], v31 offset:14592
    s_add_u32 m0, s52, 9216
    s_add_u32 s53, s43, s57
    s_waitcnt lgkmcnt(6)
    v_mfma_f32_32x32x16_bf16 v[160:175], a[64:67], a[32:35], v[160:175]
    ds_read_b64_tr_b16 a[52:53], v30 offset:14848
    ds_read_b64_tr_b16 a[54:55], v31 offset:15104
    buffer_load_dwordx4 v32, s[12:15], s53 offen offset:0 sc1 lds
    v_mfma_f32_32x32x16_bf16 v[160:175], a[68:71], a[36:39], v[160:175]
    ds_read_b64_tr_b16 a[56:57], v30 offset:16384
    ds_read_b64_tr_b16 a[58:59], v31 offset:16640
    v_mfma_f32_32x32x16_bf16 v[160:175], a[72:75], a[40:43], v[160:175]
    ds_read_b64_tr_b16 a[60:61], v30 offset:16896
    ds_read_b64_tr_b16 a[62:63], v31 offset:17152
    buffer_load_dwordx4 v32, s[12:15], s53 offen offset:1024 sc1 lds
    v_mfma_f32_32x32x16_bf16 v[160:175], a[76:79], a[44:47], v[160:175]
    ds_read_b64_tr_b16 a[64:65], v30 offset:18432
    ds_read_b64_tr_b16 a[66:67], v31 offset:18688
    s_cbranch_vccnz L_resc_11
L_rescb_12:
    s_waitcnt lgkmcnt(6)
    v_mfma_f32_32x32x16_bf16 v[64:79], a[80:83], v[216:219], v[64:79]
    ds_read_b64_tr_b16 a[68:69], v30 offset:18944
    ds_read_b64_tr_b16 a[70:71], v31 offset:19200
    buffer_load_dwordx4 v32, s[12:15], s53 offen offset:2048 sc1 lds
    v_add_f32_e64 v232, v232, v233
    v_mfma_f32_32x32x16_bf16 v[64:79], a[84:87], v[220:223], v[64:79]
    ds_read_b64_tr_b16 a[72:73], v30 offset:20480
    ds_read_b64_tr_b16 a[74:75], v31 offset:20736
    s_add_u32 m0, s52, 12288
    s_add_u32 s53, s44, s54
    v_exp_f32 v224, v160
    v_mfma_f32_32x32x16_bf16 v[80:95], a[48:51], v[216:219], v[80:95]
    ds_read_b64_tr_b16 a[76:77], v30 offset:20992
    ds_read_b64_tr_b16 a[78:79], v31 offset:21248
    buffer_load_dwordx4 v32, s[12:15], s53 offen offset:0 sc1 lds
    v_exp_f32_e64 v225, v161
    v_mfma_f32_32x32x16_bf16 v[80:95], a[52:55], v[220:223], v[80:95]
    ds_read_b64_tr_b16 a[80:81], v30 offset:22528
    ds_read_b64_tr_b16 a[82:83], v31 offset:22784
    v_exp_f32 v226, v162
    v_add_f32 v233, v224, v225
    s_waitcnt lgkmcnt(6)
    v_mfma_f32_32x32x16_bf16 v[96:111], a[56:59], v[216:219], v[96:111]
    ds_read_b64_tr_b16 a[84:85], v30 offset:23040
    ds_read_b64_tr_b16 a[86:87], v31 offset:23296
    buffer_load_dwordx4 v32, s[12:15], s53 offen offset:1024 sc1 lds
    v_cvt_pk_bf16_f32 v208, v224, v225
    v_exp_f32_e64 v227, v163
    v_mfma_f32_32x32x16_bf16 v[96:111], a[60:63], v[220:223], v[96:111]
    s_waitcnt vmcnt(11)
    ds_read_b128 a[48:51], v28 offset:0
    v_exp_f32 v228, v164
    v_add_f32 v233, v233, v226
    v_add_f32_e64 v233, v233, v227
    v_mfma_f32_32x32x16_bf16 v[112:127], a[64:67], v[216:219], v[112:127]
    ds_read_b128 a[52:55], v29 offset:1024
    buffer_load_dwordx4 v32, s[12:15], s53 offen offset:2048 sc1 lds
    v_cvt_pk_bf16_f32 v209, v226, v227
    v_exp_f32_e64 v229, v165
    v_mfma_f32_32x32x16_bf16 v[112:127], a[68:71], v[220:223], v[112:127]
    ds_read_b128 a[56:59], v28 offset:2048
    s_add_u32 m0, s52, 15360
    s_add_u32 s53, s44, s55
    v_exp_f32 v230, v166
    s_waitcnt lgkmcnt(3)
    v_mfma_f32_32x32x16_bf16 v[128:143], a[72:75], v[216:219], v[128:143]
    s_waitcnt vmcnt(9)
    ds_read_b128 a[60:63], v29 offset:3072
    buffer_load_dwordx4 v32, s[12:15], s53 offen offset:0 sc1 lds
    v_add_f32 v233, v233, v228
    v_add_f32 v233, v233, v229
    v_cvt_pk_bf16_f32 v210, v228, v229
    v_mfma_f32_32x32x16_bf16 v[128:143], a[76:79], v[220:223], v[128:143]
    ds_read_b128 a[64:67], v28 offset:4096
    v_exp_f32 v231, v167
    v_exp_f32 v224, v168
    v_add_f32_e64 v233, v233, v230
    v_mfma_f32_32x32x16_bf16 v[144:159], a[80:83], v[216:219], v[144:159]
    ds_read_b128 a[68:71], v29 offset:5120
    buffer_load_dwordx4 v32, s[12:15], s53 offen offset:1024 sc1 lds
    v_add_f32 v233, v233, v231
    v_cvt_pk_bf16_f32 v211, v230, v231
    v_exp_f32 v225, v169
    v_mfma_f32_32x32x16_bf16 v[144:159], a[84:87], v[220:223], v[144:159]
    s_waitcnt vmcnt(8)
    ds_read_b128 a[72:75], v28 offset:6144
    v_exp_f32 v226, v170
    v_add_f32 v233, v233, v224
    s_waitcnt lgkmcnt(3)
    v_mfma_f32_32x32x16_bf16 v[176:191], a[48:51], a[0:3], v[192:207]
    ds_read_b128 a[76:79], v29 offset:7168
    buffer_load_dwordx4 v32, s[12:15], s53 offen offset:2048 sc1 lds
    v_add_f32 v233, v233, v225
    v_cvt_pk_bf16_f32 v212, v224, v225
    v_exp_f32 v227, v171
    v_mfma_f32_32x32x16_bf16 v[176:191], a[52:55], a[4:7], v[176:191]
    ds_read_b128 a[80:83], v28 offset:8192
    s_add_u32 m0, s52, 18432
    s_add_u32 s53, s44, s56
    v_exp_f32 v228, v172
    v_add_f32 v233, v233, v226
    v_mfma_f32_32x32x16_bf16 v[176:191], a[56:59], a[8:11], v[176:191]
    s_waitcnt vmcnt(6)
    ds_read_b128 a[84:87], v29 offset:9216
    buffer_load_dwordx4 v32, s[12:15], s53 offen offset:0 sc1 lds
    v_add_f32 v233, v233, v227
    v_cvt_pk_bf16_f32 v213, v226, v227
    v_mfma_f32_32x32x16_bf16 v[176:191], a[60:63], a[12:15], v[176:191]
    ds_read_b128 a[48:51], v28 offset:10240
    v_exp_f32 v229, v173
    v_exp_f32 v230, v174
    s_waitcnt lgkmcnt(3)
    v_mfma_f32_32x32x16_bf16 v[176:191], a[64:67], a[16:19], v[176:191]
    ds_read_b128 a[52:55], v29 offset:11264
    buffer_load_dwordx4 v32, s[12:15], s53 offen offset:1024 sc1 lds
    v_add_f32 v233, v233, v228
    v_add_f32 v233, v233, v229
    v_cvt_pk_bf16_f32 v214, v228, v229
    v_mfma_f32_32x32x16_bf16 v[176:191], a[68:71], a[20:23], v[176:191]
    ds_read_b64_tr_b16 a[56:57], v30 offset:24576
    ds_read_b64_tr_b16 a[58:59], v31 offset:24832
    v_exp_f32 v231, v175
    v_add_f32 v233, v233, v230
    v_add_f32_e64 v233, v233, v231
    v_mfma_f32_32x32x16_bf16 v[176:191], a[72:75], a[24:27], v[176:191]
    ds_read_b64_tr_b16 a[60:61], v30 offset:25088
    ds_read_b64_tr_b16 a[62:63], v31 offset:25344
    buffer_load_dwordx4 v32, s[12:15], s53 offen offset:2048 sc1 lds
    v_cvt_pk_bf16_f32 v215, v230, v231
    v_cmp_nle_f32_e64 vcc, v233, v236
    v_mfma_f32_32x32x16_bf16 v[176:191], a[76:79], a[28:31], v[176:191]
    ds_read_b64_tr_b16 a[64:65], v30 offset:26624
    ds_read_b64_tr_b16 a[66:67], v31 offset:26880
    s_add_u32 m0, s52, 21504
    s_add_u32 s53, s44, s57
    s_waitcnt lgkmcnt(6)
    v_mfma_f32_32x32x16_bf16 v[176:191], a[80:83], a[32:35], v[176:191]
    ds_read_b64_tr_b16 a[68:69], v30 offset:27136
    ds_read_b64_tr_b16 a[70:71], v31 offset:27392
    buffer_load_dwordx4 v32, s[12:15], s53 offen offset:0 sc1 lds
    v_mfma_f32_32x32x16_bf16 v[176:191], a[84:87], a[36:39], v[176:191]
    ds_read_b64_tr_b16 a[72:73], v30 offset:28672
    ds_read_b64_tr_b16 a[74:75], v31 offset:28928
    v_mfma_f32_32x32x16_bf16 v[176:191], a[48:51], a[40:43], v[176:191]
    ds_read_b64_tr_b16 a[76:77], v30 offset:29184
    ds_read_b64_tr_b16 a[78:79], v31 offset:29440
    buffer_load_dwordx4 v32, s[12:15], s53 offen offset:1024 sc1 lds
    v_mfma_f32_32x32x16_bf16 v[176:191], a[52:55], a[44:47], v[176:191]
    ds_read_b64_tr_b16 a[80:81], v30 offset:30720
    ds_read_b64_tr_b16 a[82:83], v31 offset:30976
    s_cbranch_vccnz L_resc_13
L_rescb_14:
    s_waitcnt lgkmcnt(6)
    v_mfma_f32_32x32x16_bf16 v[64:79], a[56:59], v[208:211], v[64:79]
    ds_read_b64_tr_b16 a[84:85], v30 offset:31232
    ds_read_b64_tr_b16 a[86:87], v31 offset:31488
    buffer_load_dwordx4 v32, s[12:15], s53 offen offset:2048 sc1 lds
    v_add_f32_e64 v232, v232, v233
    v_mfma_f32_32x32x16_bf16 v[64:79], a[60:63], v[212:215], v[64:79]
    ds_read_b64_tr_b16 a[48:49], v30 offset:32768
    ds_read_b64_tr_b16 a[50:51], v31 offset:33024
    s_add_u32 m0, s52, 24576
    s_add_u32 s53, s45, s54
    v_exp_f32 v224, v176
    v_mfma_f32_32x32x16_bf16 v[80:95], a[64:67], v[208:211], v[80:95]
    ds_read_b64_tr_b16 a[52:53], v30 offset:33280
    ds_read_b64_tr_b16 a[54:55], v31 offset:33536
    buffer_load_dwordx4 v33, s[12:15], s53 offen offset:0 sc1 lds
    v_exp_f32_e64 v225, v177
    v_mfma_f32_32x32x16_bf16 v[80:95], a[68:71], v[212:215], v[80:95]
    ds_read_b64_tr_b16 a[56:57], v30 offset:34816
    ds_read_b64_tr_b16 a[58:59], v31 offset:35072
    v_exp_f32 v226, v178
    v_add_f32 v233, v224, v225
    s_waitcnt lgkmcnt(6)
    v_mfma_f32_32x32x16_bf16 v[96:111], a[72:75], v[208:211], v[96:111]
    ds_read_b64_tr_b16 a[60:61], v30 offset:35328
    ds_read_b64_tr_b16 a[62:63], v31 offset:35584
    buffer_load_dwordx4 v33, s[12:15], s53 offen offset:1024 sc1 lds
    v_cvt_pk_bf16_f32 v216, v224, v225
    v_exp_f32_e64 v227, v179
    v_mfma_f32_32x32x16_bf16 v[96:111], a[76:79], v[212:215], v[96:111]
    s_waitcnt vmcnt(11)
    ds_read_b128 a[64:67], v28 offset:12288
    v_exp_f32 v228, v180
    v_add_f32 v233, v233, v226
    v_add_f32_e64 v233, v233, v227
    v_mfma_f32_32x32x16_bf16 v[112:127], a[80:83], v[208:211], v[112:127]
    ds_read_b128 a[68:71], v29 offset:13312
    buffer_load_dwordx4 v33, s[12:15], s53 offen offset:2048 sc1 lds
    v_cvt_pk_bf16_f32 v217, v226, v227
    v_exp_f32_e64 v229, v181
    v_mfma_f32_32x32x16_bf16 v[112:127], a[84:87], v[212:215], v[112:127]
    ds_read_b128 a[72:75], v28 offset:14336
    s_add_u32 m0, s52, 27648
    s_add_u32 s53, s45, s55
    v_exp_f32 v230, v182
    s_waitcnt lgkmcnt(3)
    v_mfma_f32_32x32x16_bf16 v[128:143], a[48:51], v[208:211], v[128:143]
    s_waitcnt vmcnt(9)
    ds_read_b128 a[76:79], v29 offset:15360
    buffer_load_dwordx4 v33, s[12:15], s53 offen offset:0 sc1 lds
    v_add_f32 v233, v233, v228
    v_add_f32 v233, v233, v229
    v_cvt_pk_bf16_f32 v218, v228, v229
    v_mfma_f32_32x32x16_bf16 v[128:143], a[52:55], v[212:215], v[128:143]
    ds_read_b128 a[80:83], v28 offset:16384
    v_exp_f32 v231, v183
    v_exp_f32 v224, v184
    v_add_f32_e64 v233, v233, v230
    v_mfma_f32_32x32x16_bf16 v[144:159], a[56:59], v[208:211], v[144:159]
    ds_read_b128 a[84:87], v29 offset:17408
    buffer_load_dwordx4 v33, s[12:15], s53 offen offset:1024 sc1 lds
    v_add_f32 v233, v233, v231
    v_cvt_pk_bf16_f32 v219, v230, v231
    v_exp_f32 v225, v185
    v_mfma_f32_32x32x16_bf16 v[144:159], a[60:63], v[212:215], v[144:159]
    s_waitcnt vmcnt(8)
    ds_read_b128 a[48:51], v28 offset:18432
    v_exp_f32 v226, v186
    v_add_f32 v233, v233, v224
    s_waitcnt lgkmcnt(3)
    v_mfma_f32_32x32x16_bf16 v[160:175], a[64:67], a[0:3], v[192:207]
    ds_read_b128 a[52:55], v29 offset:19456
    buffer_load_dwordx4 v33, s[12:15], s53 offen offset:2048 sc1 lds
    v_add_f32 v233, v233, v225
    v_cvt_pk_bf16_f32 v220, v224, v225
    v_exp_f32 v227, v187
    v_mfma_f32_32x32x16_bf16 v[160:175], a[68:71], a[4:7], v[160:175]
    ds_read_b128 a[56:59], v28 offset:20480
    s_add_u32 m0, s52, 30720
    s_add_u32 s53, s45, s56
    v_exp_f32 v228, v188
    v_add_f32 v233, v233, v226
    v_mfma_f32_32x32x16_bf16 v[160:175], a[72:75], a[8:11], v[160:175]
    s_waitcnt vmcnt(6)
    ds_read_b128 a[60:63], v29 offset:21504
    buffer_load_dwordx4 v33, s[12:15], s53 offen offset:0 sc1 lds
    v_add_f32 v233, v233, v227
    v_cvt_pk_bf16_f32 v221, v226, v227
    v_mfma_f32_32x32x16_bf16 v[160:175], a[76:79], a[12:15], v[160:175]
    ds_read_b128 a[64:67], v28 offset:22528
    v_exp_f32 v229, v189
    v_exp_f32 v230, v190
    s_waitcnt lgkmcnt(3)
    v_mfma_f32_32x32x16_bf16 v[160:175], a[80:83], a[16:19], v[160:175]
    ds_read_b128 a[68:71], v29 offset:23552
    buffer_load_dwordx4 v33, s[12:15], s53 offen offset:1024 sc1 lds
    v_add_f32 v233, v233, v228
    v_add_f32 v233, v233, v229
    v_cvt_pk_bf16_f32 v222, v228, v229
    v_mfma_f32_32x32x16_bf16 v[160:175], a[84:87], a[20:23], v[160:175]
    ds_read_b64_tr_b16 a[72:73], v30 offset:0
    ds_read_b64_tr_b16 a[74:75], v31 offset:256
    v_exp_f32 v231, v191
    v_add_f32 v233, v233, v230
    v_add_f32_e64 v233, v233, v231
    v_mfma_f32_32x32x16_bf16 v[160:175], a[48:51], a[24:27], v[160:175]
    ds_read_b64_tr_b16 a[76:77], v30 offset:512
    ds_read_b64_tr_b16 a[78:79], v31 offset:768
    buffer_load_dwordx4 v33, s[12:15], s53 offen offset:2048 sc1 lds
    v_cvt_pk_bf16_f32 v223, v230, v231
    v_cmp_nle_f32_e64 vcc, v233, v236
    v_mfma_f32_32x32x16_bf16 v[160:175], a[52:55], a[28:31], v[160:175]
    ds_read_b64_tr_b16 a[80:81], v30 offset:2048
    ds_read_b64_tr_b16 a[82:83], v31 offset:2304
    s_add_u32 m0, s52, 33792
    s_add_u32 s53, s45, s57
    s_waitcnt lgkmcnt(6)
    v_mfma_f32_32x32x16_bf16 v[160:175], a[56:59], a[32:35], v[160:175]
    ds_read_b64_tr_b16 a[84:85], v30 offset:2560
    ds_read_b64_tr_b16 a[86:87], v31 offset:2816
    buffer_load_dwordx4 v33, s[12:15], s53 offen offset:0 sc1 lds
    v_mfma_f32_32x32x16_bf16 v[160:175], a[60:63], a[36:39], v[160:175]
    ds_read_b64_tr_b16 a[48:49], v30 offset:4096
    ds_read_b64_tr_b16 a[50:51], v31 offset:4352
    v_mfma_f32_32x32x16_bf16 v[160:175], a[64:67], a[40:43], v[160:175]
    ds_read_b64_tr_b16 a[52:53], v30 offset:4608
    ds_read_b64_tr_b16 a[54:55], v31 offset:4864
    buffer_load_dwordx4 v33, s[12:15], s53 offen offset:1024 sc1 lds
    v_mfma_f32_32x32x16_bf16 v[160:175], a[68:71], a[44:47], v[160:175]
    ds_read_b64_tr_b16 a[56:57], v30 offset:6144
    ds_read_b64_tr_b16 a[58:59], v31 offset:6400
    s_cbranch_vccnz L_resc_15
L_rescb_16:
    s_waitcnt lgkmcnt(6)
    v_mfma_f32_32x32x16_bf16 v[64:79], a[72:75], v[216:219], v[64:79]
    ds_read_b64_tr_b16 a[60:61], v30 offset:6656
    ds_read_b64_tr_b16 a[62:63], v31 offset:6912
    buffer_load_dwordx4 v33, s[12:15], s53 offen offset:2048 sc1 lds
    v_cmp_lt_u32 s[76:77], 31, v1
    v_add_f32 v192, s48, v192
    v_add_f32 v232, v232, v233
    v_mfma_f32_32x32x16_bf16 v[64:79], a[76:79], v[220:223], v[64:79]
    ds_read_b64_tr_b16 a[64:65], v30 offset:8192
    ds_read_b64_tr_b16 a[66:67], v31 offset:8448
    v_add_f32 v193, s48, v193
    v_add_f32 v194, s48, v194
    v_add_f32 v195, s48, v195
    v_add_f32 v196, s48, v196
    v_mfma_f32_32x32x16_bf16 v[80:95], a[80:83], v[216:219], v[80:95]
    ds_read_b64_tr_b16 a[68:69], v30 offset:8704
    ds_read_b64_tr_b16 a[70:71], v31 offset:8960
    buffer_load_dwordx2 v[252:253], v63, s[12:15], s50 offen offset:0 sc1
    v_add_f32 v197, s48, v197
    v_add_f32 v198, s48, v198
    v_add_f32_e64 v199, s48, v199
    v_mfma_f32_32x32x16_bf16 v[80:95], a[84:87], v[220:223], v[80:95]
    ds_read_b64_tr_b16 a[72:73], v30 offset:10240
    ds_read_b64_tr_b16 a[74:75], v31 offset:10496
    buffer_load_dwordx2 v[254:255], v63, s[12:15], s50 offen offset:1024 sc1
    v_add_f32 v200, s48, v200
    v_add_f32_e64 v201, s48, v201
    s_waitcnt lgkmcnt(6)
    v_mfma_f32_32x32x16_bf16 v[96:111], a[48:51], v[216:219], v[96:111]
    ds_read_b64_tr_b16 a[76:77], v30 offset:10752
    ds_read_b64_tr_b16 a[78:79], v31 offset:11008
    v_add_f32 v202, s48, v202
    v_add_f32 v203, s48, v203
    v_add_f32 v204, s48, v204
    v_add_f32_e64 v205, s49, v205
    v_mfma_f32_32x32x16_bf16 v[96:111], a[52:55], v[220:223], v[96:111]
    s_waitcnt vmcnt(11)
    ds_read_b128 a[80:83], v28 offset:24576
    s_add_u32 s79, s78, 2099200
    buffer_load_dwordx4 a[184:187], v32, s[12:15], s79 offen offset:0 sc1
    v_add_f32 v206, s49, v206
    v_add_f32 v207, s49, v207
    v_add_f32_e64 v235, s49, v204
    v_mfma_f32_32x32x16_bf16 v[112:127], a[56:59], v[216:219], v[112:127]
    ds_read_b128 a[84:87], v29 offset:25600
    buffer_load_dwordx4 a[188:191], v32, s[12:15], s79 offen offset:1024 sc1
    v_cndmask_b32 v204, v204, v235, s[76:77]
    v_exp_f32 v224, v160
    v_mfma_f32_32x32x16_bf16 v[112:127], a[60:63], v[220:223], v[112:127]
    ds_read_b128 a[48:51], v28 offset:26624
    v_exp_f32 v225, v161
    v_exp_f32 v226, v162
    s_waitcnt lgkmcnt(3)
    v_mfma_f32_32x32x16_bf16 v[128:143], a[64:67], v[216:219], v[128:143]
    s_waitcnt vmcnt(10)
    ds_read_b128 a[52:55], v29 offset:27648
    buffer_load_dwordx4 a[192:195], v32, s[12:15], s79 offen offset:2048 sc1
    v_add_f32 v233, v224, v225
    v_cvt_pk_bf16_f32 v208, v224, v225
    v_mfma_f32_32x32x16_bf16 v[128:143], a[68:71], v[220:223], v[128:143]
    ds_read_b128 a[56:59], v28 offset:28672
    v_exp_f32 v227, v163
    v_exp_f32 v228, v164
    v_add_f32 v233, v233, v226
    v_mfma_f32_32x32x16_bf16 v[144:159], a[72:75], v[216:219], v[144:159]
    ds_read_b128 a[60:63], v29 offset:29696
    buffer_load_dwordx4 a[196:199], v32, s[12:15], s79 offen offset:3072 sc1
    v_add_f32 v233, v233, v227
    v_cvt_pk_bf16_f32 v209, v226, v227
    v_exp_f32 v229, v165
    v_mfma_f32_32x32x16_bf16 v[144:159], a[76:79], v[220:223], v[144:159]
    s_waitcnt vmcnt(9)
    ds_read_b128 a[64:67], v28 offset:30720
    s_add_u32 s79, s78, 2103296
    buffer_load_dwordx4 a[200:203], v32, s[12:15], s79 offen offset:0 sc1
    v_exp_f32 v230, v166
    s_waitcnt lgkmcnt(3)
    v_mfma_f32_32x32x16_bf16 v[176:191], a[80:83], a[0:3], v[192:207]
    ds_read_b128 a[68:71], v29 offset:31744
    v_add_f32 v233, v233, v228
    v_add_f32 v233, v233, v229
    v_cvt_pk_bf16_f32 v210, v228, v229
    v_exp_f32_e64 v231, v167
    v_mfma_f32_32x32x16_bf16 v[176:191], a[84:87], a[4:7], v[176:191]
    ds_read_b128 a[72:75], v28 offset:32768
    buffer_load_dwordx4 a[204:207], v32, s[12:15], s79 offen offset:1024 sc1
    v_exp_f32 v224, v168
    v_add_f32 v233, v233, v230
    v_add_f32 v233, v233, v231
    v_mfma_f32_32x32x16_bf16 v[176:191], a[48:51], a[8:11], v[176:191]
    s_waitcnt vmcnt(8)
    ds_read_b128 a[76:79], v29 offset:33792
    v_cvt_pk_bf16_f32 v211, v230, v231
    v_exp_f32 v225, v169
    v_mfma_f32_32x32x16_bf16 v[176:191], a[52:55], a[12:15], v[176:191]
    ds_read_b128 a[80:83], v28 offset:34816
    buffer_load_dwordx4 a[208:211], v32, s[12:15], s79 offen offset:2048 sc1
    v_exp_f32 v226, v170
    v_add_f32 v233, v233, v224
    s_waitcnt lgkmcnt(3)
    v_mfma_f32_32x32x16_bf16 v[176:191], a[56:59], a[16:19], v[176:191]
    ds_read_b128 a[84:87], v29 offset:35840
    buffer_load_dwordx4 a[212:215], v32, s[12:15], s79 offen offset:3072 sc1
    v_add_f32 v233, v233, v225
    v_cvt_pk_bf16_f32 v212, v224, v225
    v_exp_f32 v227, v171
    v_mfma_f32_32x32x16_bf16 v[176:191], a[60:63], a[20:23], v[176:191]
    ds_read_b64_tr_b16 a[48:49], v30 offset:12288
    ds_read_b64_tr_b16 a[50:51], v31 offset:12544
    v_exp_f32 v228, v172
    v_add_f32 v233, v233, v226
    v_add_f32_e64 v233, v233, v227
    v_mfma_f32_32x32x16_bf16 v[176:191], a[64:67], a[24:27], v[176:191]
    ds_read_b64_tr_b16 a[52:53], v30 offset:12800
L_page3:
    s_cbranch_execz L_pageret3
    ds_read_b64_tr_b16 a[54:55], v31 offset:13056
    s_add_u32 s79, s78, 2107392
    buffer_load_dwordx4 a[216:219], v32, s[12:15], s79 offen offset:0 sc1
    v_cvt_pk_bf16_f32 v213, v226, v227
    v_exp_f32 v229, v173
    v_mfma_f32_32x32x16_bf16 v[176:191], a[68:71], a[28:31], v[176:191]
    ds_read_b64_tr_b16 a[56:57], v30 offset:14336
    ds_read_b64_tr_b16 a[58:59], v31 offset:14592
    v_exp_f32 v230, v174
    v_add_f32_e64 v233, v233, v228
    s_waitcnt lgkmcnt(6)
    v_mfma_f32_32x32x16_bf16 v[176:191], a[72:75], a[32:35], v[176:191]
    ds_read_b64_tr_b16 a[60:61], v30 offset:14848
    ds_read_b64_tr_b16 a[62:63], v31 offset:15104
    buffer_load_dwordx4 a[220:223], v32, s[12:15], s79 offen offset:1024 sc1
    v_add_f32_e64 v233, v233, v229
    v_cvt_pk_bf16_f32 v214, v228, v229
    v_mfma_f32_32x32x16_bf16 v[176:191], a[76:79], a[36:39], v[176:191]
    ds_read_b64_tr_b16 a[64:65], v30 offset:16384
    ds_read_b64_tr_b16 a[66:67], v31 offset:16640
    buffer_load_dwordx4 a[224:227], v32, s[12:15], s79 offen offset:2048 sc1
    v_exp_f32 v231, v175
    v_add_f32 v233, v233, v230
    v_mfma_f32_32x32x16_bf16 v[176:191], a[80:83], a[40:43], v[176:191]
    ds_read_b64_tr_b16 a[68:69], v30 offset:16896
    ds_read_b64_tr_b16 a[70:71], v31 offset:17152
    v_add_f32 v233, v233, v231
    v_cvt_pk_bf16_f32 v215, v230, v231
    v_cmp_nle_f32 vcc, v233, v236
    v_mfma_f32_32x32x16_bf16 v[176:191], a[84:87], a[44:47], v[176:191]
    ds_read_b64_tr_b16 a[72:73], v30 offset:18432
    ds_read_b64_tr_b16 a[74:75], v31 offset:18688
    buffer_load_dwordx4 a[228:231], v32, s[12:15], s79 offen offset:3072 sc1
    s_cbranch_vccnz L_resc_17
L_rescb_18:
    s_waitcnt lgkmcnt(6)
    v_mfma_f32_32x32x16_bf16 v[64:79], a[48:51], v[208:211], v[64:79]
    ds_read_b64_tr_b16 a[76:77], v30 offset:18944
    ds_read_b64_tr_b16 a[78:79], v31 offset:19200
    v_add_f32_e64 v232, v232, v233
    v_mfma_f32_32x32x16_bf16 v[64:79], a[52:55], v[212:215], v[64:79]
    ds_read_b64_tr_b16 a[80:81], v30 offset:20480
    ds_read_b64_tr_b16 a[82:83], v31 offset:20736
    s_add_u32 s79, s78, 2111488
    buffer_load_dwordx4 a[232:235], v32, s[12:15], s79 offen offset:0 sc1
    v_exp_f32 v224, v176
    v_exp_f32 v225, v177
    v_exp_f32_e64 v226, v178
    v_mfma_f32_32x32x16_bf16 v[80:95], a[56:59], v[208:211], v[80:95]
    ds_read_b64_tr_b16 a[84:85], v30 offset:20992
    ds_read_b64_tr_b16 a[86:87], v31 offset:21248
    buffer_load_dwordx4 a[236:239], v32, s[12:15], s79 offen offset:1024 sc1
    v_add_f32_e64 v233, v224, v225
    v_cvt_pk_bf16_f32 v216, v224, v225
    v_exp_f32 v227, v179
    v_exp_f32 v228, v180
    v_mfma_f32_32x32x16_bf16 v[80:95], a[60:63], v[212:215], v[80:95]
    ds_read_b64_tr_b16 a[48:49], v30 offset:22528
    ds_read_b64_tr_b16 a[50:51], v31 offset:22784
    v_add_f32 v233, v233, v226
    v_add_f32 v233, v233, v227
    v_cvt_pk_bf16_f32 v217, v226, v227
    v_exp_f32 v229, v181
    s_waitcnt lgkmcnt(6)
    v_mfma_f32_32x32x16_bf16 v[96:111], a[64:67], v[208:211], v[96:111]
    ds_read_b64_tr_b16 a[52:53], v30 offset:23040
    ds_read_b64_tr_b16 a[54:55], v31 offset:23296
    buffer_load_dwordx4 a[240:243], v32, s[12:15], s79 offen offset:2048 sc1
    v_exp_f32 v230, v182
    v_add_f32 v233, v233, v228
    v_add_f32_e64 v233, v233, v229
    v_cvt_pk_bf16_f32 v218, v228, v229
    v_mfma_f32_32x32x16_bf16 v[96:111], a[68:71], v[212:215], v[96:111]
    ds_read_b64_tr_b16 a[56:57], v30 offset:34816
    ds_read_b64_tr_b16 a[58:59], v31 offset:35072
    v_exp_f32 v231, v183
    v_exp_f32 v224, v184
    v_add_f32 v233, v233, v230
    v_add_f32 v233, v233, v231
    v_cvt_pk_bf16_f32 v219, v230, v231
    v_mfma_f32_32x32x16_bf16 v[112:127], a[72:75], v[208:211], v[112:127]
    ds_read_b64_tr_b16 a[60:61], v30 offset:35328
    ds_read_b64_tr_b16 a[62:63], v31 offset:35584
    buffer_load_dwordx4 a[244:247], v32, s[12:15], s79 offen offset:3072 sc1
    v_exp_f32 v225, v185
    v_exp_f32 v226, v186
    v_add_f32 v233, v233, v224
    v_add_f32 v233, v233, v225
    v_mfma_f32_32x32x16_bf16 v[112:127], a[76:79], v[212:215], v[112:127]
    ds_read_b64_tr_b16 a[64:65], v30 offset:32768
    ds_read_b64_tr_b16 a[66:67], v31 offset:33024
    s_add_u32 s79, s78, 2115584
    buffer_load_dwordx4 a[248:251], v32, s[12:15], s79 offen offset:0 sc1
    v_cvt_pk_bf16_f32 v220, v224, v225
    v_exp_f32 v227, v187
    v_exp_f32_e64 v228, v188
    s_waitcnt lgkmcnt(6)
    v_mfma_f32_32x32x16_bf16 v[128:143], a[80:83], v[208:211], v[128:143]
    ds_read_b64_tr_b16 a[68:69], v30 offset:33280
    ds_read_b64_tr_b16 a[70:71], v31 offset:33536
    v_add_f32 v233, v233, v226
    v_add_f32 v233, v233, v227
    v_cvt_pk_bf16_f32 v221, v226, v227
    v_exp_f32 v229, v189
    v_exp_f32 v230, v190
    v_mfma_f32_32x32x16_bf16 v[128:143], a[84:87], v[212:215], v[128:143]
    ds_read_b64_tr_b16 a[72:73], v30 offset:30720
    ds_read_b64_tr_b16 a[74:75], v31 offset:30976
    buffer_load_dwordx4 a[252:255], v32, s[12:15], s79 offen offset:1024 sc1
    v_add_f32 v233, v233, v228
    v_add_f32 v233, v233, v229
    v_cvt_pk_bf16_f32 v222, v228, v229
    v_exp_f32 v231, v191
    v_add_f32 v233, v233, v230
    v_mfma_f32_32x32x16_bf16 v[144:159], a[48:51], v[208:211], v[144:159]
    ds_read_b64_tr_b16 a[76:77], v30 offset:31232
    ds_read_b64_tr_b16 a[78:79], v31 offset:31488
    v_add_f32_e64 v233, v233, v231
    v_cvt_pk_bf16_f32 v223, v230, v231
    v_cmp_nle_f32_e64 vcc, v233, v236
    v_mfma_f32_32x32x16_bf16 v[144:159], a[52:55], v[212:215], v[144:159]
    ds_read_b64_tr_b16 a[80:81], v30 offset:28672
    ds_read_b64_tr_b16 a[82:83], v31 offset:28928
    s_cbranch_vccnz L_resc_19
L_rescb_20:
    s_waitcnt lgkmcnt(6)
    v_mfma_f32_32x32x16_bf16 v[144:159], a[56:59], v[216:219], v[144:159]
    ds_read_b64_tr_b16 a[84:85], v30 offset:29184
    ds_read_b64_tr_b16 a[86:87], v31 offset:29440
    v_add_f32 v232, v232, v233
    v_mov_b32 v235, v232
    v_mfma_f32_32x32x16_bf16 v[144:159], a[60:63], v[220:223], v[144:159]
    ds_read_b64_tr_b16 a[48:49], v30 offset:26624
    ds_read_b64_tr_b16 a[50:51], v31 offset:26880
    v_permlane32_swap_b32 v235, v232
    v_add_f32 v235, v232, v235
    v_mfma_f32_32x32x16_bf16 v[128:143], a[64:67], v[216:219], v[128:143]
    ds_write_b64 v48, v[234:235]
    ds_read_b64_tr_b16 a[52:53], v30 offset:27136
    ds_read_b64_tr_b16 a[54:55], v31 offset:27392
    v_mfma_f32_32x32x16_bf16 v[128:143], a[68:71], v[220:223], v[128:143]
    ds_read_b64_tr_b16 a[56:57], v30 offset:24576
    ds_read_b64_tr_b16 a[58:59], v31 offset:24832
    s_nop 0
    v_cvt_pk_f16_f32 v188, v144, v145
    v_cvt_pk_f16_f32 v189, v146, v147
    v_cvt_pk_f16_f32 v190, v148, v149
    s_waitcnt lgkmcnt(7)
    v_mfma_f32_32x32x16_bf16 v[112:127], a[72:75], v[216:219], v[112:127]
    s_waitcnt lgkmcnt(4)
    s_barrier
    ds_read_b64 v[224:225], v49
    ds_read_b64 v[226:227], v50
    ds_read_b64 v[228:229], v51
    ds_read_b64_tr_b16 a[60:61], v30 offset:25088
    ds_read_b64_tr_b16 a[62:63], v31 offset:25344
    v_mfma_f32_32x32x16_bf16 v[112:127], a[76:79], v[220:223], v[112:127]
    v_cvt_pk_f16_f32 v191, v150, v151
    v_cvt_pk_f16_f32 v192, v152, v153
    v_cvt_pk_f16_f32 v193, v154, v155
    v_cvt_pk_f16_f32 v194, v156, v157
    v_cvt_pk_f16_f32 v195, v158, v159
    v_cvt_pk_f16_f32 v180, v128, v129
    v_mfma_f32_32x32x16_bf16 v[96:111], a[80:83], v[216:219], v[96:111]
    ds_write_b128 v44, v[188:191] offset:10240
    v_cvt_pk_f16_f32 v181, v130, v131
    v_cvt_pk_f16_f32 v182, v132, v133
    v_cvt_pk_f16_f32 v183, v134, v135
    v_cvt_pk_f16_f32 v184, v136, v137
    v_cvt_pk_f16_f32 v185, v138, v139
    v_mfma_f32_32x32x16_bf16 v[96:111], a[84:87], v[220:223], v[96:111]
    ds_write_b128 v44, v[192:195] offset:11264
    v_cvt_pk_f16_f32 v186, v140, v141
    v_cvt_pk_f16_f32 v187, v142, v143
    v_cvt_pk_f16_f32 v172, v112, v113
    v_cvt_pk_f16_f32 v173, v114, v115
    s_waitcnt lgkmcnt(2)
    v_mfma_f32_32x32x16_bf16 v[80:95], a[48:51], v[216:219], v[80:95]
    ds_write_b128 v44, v[180:183] offset:8192
    v_cvt_pk_f16_f32 v174, v116, v117
    v_cvt_pk_f16_f32 v175, v118, v119
    v_cvt_pk_f16_f32 v176, v120, v121
    v_cvt_pk_f16_f32 v177, v122, v123
    v_cvt_pk_f16_f32 v178, v124, v125
    v_mfma_f32_32x32x16_bf16 v[80:95], a[52:55], v[220:223], v[80:95]
    ds_write_b128 v44, v[184:187] offset:9216
    v_cvt_pk_f16_f32 v179, v126, v127
    v_cvt_pk_f16_f32 v164, v96, v97
    v_cvt_pk_f16_f32 v165, v98, v99
    v_cvt_pk_f16_f32 v166, v100, v101
    v_cvt_pk_f16_f32 v167, v102, v103
    v_mfma_f32_32x32x16_bf16 v[64:79], a[56:59], v[216:219], v[64:79]
    ds_write_b128 v44, v[172:175] offset:6144
    v_cvt_pk_f16_f32 v168, v104, v105
    v_cvt_pk_f16_f32 v169, v106, v107
    v_cvt_pk_f16_f32 v170, v108, v109
    v_cvt_pk_f16_f32 v171, v110, v111
    v_mfma_f32_32x32x16_bf16 v[64:79], a[60:63], v[220:223], v[64:79]
    ds_write_b128 v44, v[176:179] offset:7168
    v_cvt_pk_f16_f32 v160, v88, v89
    v_cvt_pk_f16_f32 v161, v90, v91
    v_cvt_pk_f16_f32 v162, v92, v93
    v_cvt_pk_f16_f32 v163, v94, v95
    ds_write_b128 v44, v[164:167] offset:4096
    ds_write_b128 v44, v[168:171] offset:5120
    ds_write_b128 v44, v[160:163] offset:3072
    v_max3_f32 v230, v234, v224, v226
    v_max_f32 v230, v230, v228
    v_sub_f32 v234, v234, v230
    v_sub_f32 v224, v224, v230
    v_sub_f32 v226, v226, v230
    v_sub_f32 v228, v228, v230
    v_exp_f32 v234, v234
    v_exp_f32 v224, v224
    v_mul_f32 v230, v234, v235
    v_exp_f32 v226, v226
    v_fmac_f32 v230, v224, v225
    v_exp_f32 v228, v228
    v_fmac_f32 v230, v226, v227
    v_fmac_f32 v230, v228, v229
    v_rcp_f32 v230, v230
    s_waitcnt vmcnt(19)
    v_pk_fma_f32 v[4:5], v[4:5], v[252:253], v[252:253] op_sel:[0,1,0] op_sel_hi:[1,1,0]
    v_mul_f32 v234, v234, v230
    v_mul_f32 v224, v224, v230
    v_pk_mul_f32 v[64:65], v[64:65], v[234:235] op_sel_hi:[1,0]
    v_pk_mul_f32 v[66:67], v[66:67], v[234:235] op_sel_hi:[1,0]
    v_pk_mul_f32 v[68:69], v[68:69], v[234:235] op_sel_hi:[1,0]
    v_pk_mul_f32 v[70:71], v[70:71], v[234:235] op_sel_hi:[1,0]
    v_pk_mul_f32 v[72:73], v[72:73], v[234:235] op_sel_hi:[1,0]
    v_pk_mul_f32 v[74:75], v[74:75], v[234:235] op_sel_hi:[1,0]
    v_pk_mul_f32 v[76:77], v[76:77], v[234:235] op_sel_hi:[1,0]
    v_pk_mul_f32 v[78:79], v[78:79], v[234:235] op_sel_hi:[1,0]
    v_pk_mul_f32 v[80:81], v[80:81], v[234:235] op_sel_hi:[1,0]
    v_pk_mul_f32 v[82:83], v[82:83], v[234:235] op_sel_hi:[1,0]
    v_pk_mul_f32 v[84:85], v[84:85], v[234:235] op_sel_hi:[1,0]
    v_pk_mul_f32 v[86:87], v[86:87], v[234:235] op_sel_hi:[1,0]
    v_mul_f32 v226, v226, v230
    v_mul_f32_e64 v228, v228, v230
    v_pk_fma_f32 v[6:7], v[6:7], v[252:253], v[252:253] op_sel:[0,1,0] op_sel_hi:[1,1,0]
    s_waitcnt vmcnt(18)
    v_pk_fma_f32 v[8:9], v[8:9], v[254:255], v[254:255] op_sel:[0,1,0] op_sel_hi:[1,1,0]
    v_pk_fma_f32 v[10:11], v[10:11], v[254:255], v[254:255] op_sel:[0,1,0] op_sel_hi:[1,1,0]
    v_pk_fma_f32 v[12:13], v[12:13], v[252:253], v[252:253] op_sel:[0,1,0] op_sel_hi:[1,1,0]
    v_pk_fma_f32 v[14:15], v[14:15], v[252:253], v[252:253] op_sel:[0,1,0] op_sel_hi:[1,1,0]
    v_pk_fma_f32 v[16:17], v[16:17], v[254:255], v[254:255] op_sel:[0,1,0] op_sel_hi:[1,1,0]
    v_pk_fma_f32 v[18:19], v[18:19], v[254:255], v[254:255] op_sel:[0,1,0] op_sel_hi:[1,1,0]
    v_pk_fma_f32 v[20:21], v[20:21], v[252:253], v[252:253] op_sel:[0,1,0] op_sel_hi:[1,1,0]
    v_pk_fma_f32 v[22:23], v[22:23], v[252:253], v[252:253] op_sel:[0,1,0] op_sel_hi:[1,1,0]
    v_pk_fma_f32 v[24:25], v[24:25], v[254:255], v[254:255] op_sel:[0,1,0] op_sel_hi:[1,1,0]
    s_waitcnt lgkmcnt(0)
    s_barrier
    ds_read_b128 v[88:91], v45 offset:3072
    ds_read_b128 v[92:95], v45 offset:4096
    ds_read_b128 v[96:99], v45 offset:5120
    ds_read_b128 v[100:103], v46 offset:6144
    ds_read_b128 v[104:107], v46 offset:7168
    ds_read_b128 v[108:111], v46 offset:8192
    ds_read_b128 v[112:115], v47 offset:9216
    ds_read_b128 v[116:119], v47 offset:10240
    ds_read_b128 v[120:123], v47 offset:11264
    v_pk_fma_f32 v[26:27], v[26:27], v[254:255], v[254:255] op_sel:[0,1,0] op_sel_hi:[1,1,0]
    s_waitcnt lgkmcnt(7)
    v_fma_mix_f32 v64, v88, v224, v64 op_sel:[0,0,0] op_sel_hi:[1,0,0]
    v_fma_mix_f32 v65, v88, v224, v65 op_sel:[1,0,0] op_sel_hi:[1,0,0]
    v_fma_mix_f32 v66, v89, v224, v66 op_sel:[0,0,0] op_sel_hi:[1,0,0]
    v_fma_mix_f32 v67, v89, v224, v67 op_sel:[1,0,0] op_sel_hi:[1,0,0]
    v_fma_mix_f32 v68, v90, v224, v68 op_sel:[0,0,0] op_sel_hi:[1,0,0]
    v_fma_mix_f32 v69, v90, v224, v69 op_sel:[1,0,0] op_sel_hi:[1,0,0]
    v_fma_mix_f32 v70, v91, v224, v70 op_sel:[0,0,0] op_sel_hi:[1,0,0]
    v_fma_mix_f32 v71, v91, v224, v71 op_sel:[1,0,0] op_sel_hi:[1,0,0]
    v_fma_mix_f32 v72, v92, v224, v72 op_sel:[0,0,0] op_sel_hi:[1,0,0]
    v_fma_mix_f32 v73, v92, v224, v73 op_sel:[1,0,0] op_sel_hi:[1,0,0]
    v_fma_mix_f32 v74, v93, v224, v74 op_sel:[0,0,0] op_sel_hi:[1,0,0]
    v_fma_mix_f32 v75, v93, v224, v75 op_sel:[1,0,0] op_sel_hi:[1,0,0]
    v_fma_mix_f32 v76, v94, v224, v76 op_sel:[0,0,0] op_sel_hi:[1,0,0]
    v_fma_mix_f32 v77, v94, v224, v77 op_sel:[1,0,0] op_sel_hi:[1,0,0]
    v_fma_mix_f32 v78, v95, v224, v78 op_sel:[0,0,0] op_sel_hi:[1,0,0]
    v_fma_mix_f32 v79, v95, v224, v79 op_sel:[1,0,0] op_sel_hi:[1,0,0]
    s_waitcnt lgkmcnt(0)
    v_fma_mix_f32 v80, v96, v224, v80 op_sel:[0,0,0] op_sel_hi:[1,0,0]
    v_fma_mix_f32 v81, v96, v224, v81 op_sel:[1,0,0] op_sel_hi:[1,0,0]
    v_fma_mix_f32 v82, v97, v224, v82 op_sel:[0,0,0] op_sel_hi:[1,0,0]
    v_fma_mix_f32 v83, v97, v224, v83 op_sel:[1,0,0] op_sel_hi:[1,0,0]
    v_fma_mix_f32 v84, v98, v224, v84 op_sel:[0,0,0] op_sel_hi:[1,0,0]
    v_fma_mix_f32 v85, v98, v224, v85 op_sel:[1,0,0] op_sel_hi:[1,0,0]
    v_fma_mix_f32 v86, v99, v224, v86 op_sel:[0,0,0] op_sel_hi:[1,0,0]
    v_fma_mix_f32 v87, v99, v224, v87 op_sel:[1,0,0] op_sel_hi:[1,0,0]
    v_fma_mix_f32 v64, v100, v226, v64 op_sel:[0,0,0] op_sel_hi:[1,0,0]
    v_fma_mix_f32 v65, v100, v226, v65 op_sel:[1,0,0] op_sel_hi:[1,0,0]
    v_fma_mix_f32 v66, v101, v226, v66 op_sel:[0,0,0] op_sel_hi:[1,0,0]
    v_fma_mix_f32 v67, v101, v226, v67 op_sel:[1,0,0] op_sel_hi:[1,0,0]
    v_fma_mix_f32 v68, v102, v226, v68 op_sel:[0,0,0] op_sel_hi:[1,0,0]
    v_fma_mix_f32 v69, v102, v226, v69 op_sel:[1,0,0] op_sel_hi:[1,0,0]
    v_fma_mix_f32 v70, v103, v226, v70 op_sel:[0,0,0] op_sel_hi:[1,0,0]
    v_fma_mix_f32 v71, v103, v226, v71 op_sel:[1,0,0] op_sel_hi:[1,0,0]
    v_fma_mix_f32 v72, v104, v226, v72 op_sel:[0,0,0] op_sel_hi:[1,0,0]
    v_fma_mix_f32 v73, v104, v226, v73 op_sel:[1,0,0] op_sel_hi:[1,0,0]
    v_fma_mix_f32 v74, v105, v226, v74 op_sel:[0,0,0] op_sel_hi:[1,0,0]
    v_fma_mix_f32 v75, v105, v226, v75 op_sel:[1,0,0] op_sel_hi:[1,0,0]
    v_fma_mix_f32 v76, v106, v226, v76 op_sel:[0,0,0] op_sel_hi:[1,0,0]
    v_fma_mix_f32 v77, v106, v226, v77 op_sel:[1,0,0] op_sel_hi:[1,0,0]
    v_fma_mix_f32 v78, v107, v226, v78 op_sel:[0,0,0] op_sel_hi:[1,0,0]
    v_fma_mix_f32 v79, v107, v226, v79 op_sel:[1,0,0] op_sel_hi:[1,0,0]
    v_fma_mix_f32 v80, v108, v226, v80 op_sel:[0,0,0] op_sel_hi:[1,0,0]
    v_fma_mix_f32 v81, v108, v226, v81 op_sel:[1,0,0] op_sel_hi:[1,0,0]
    v_fma_mix_f32 v82, v109, v226, v82 op_sel:[0,0,0] op_sel_hi:[1,0,0]
    v_fma_mix_f32 v83, v109, v226, v83 op_sel:[1,0,0] op_sel_hi:[1,0,0]
    v_fma_mix_f32 v84, v110, v226, v84 op_sel:[0,0,0] op_sel_hi:[1,0,0]
    v_fma_mix_f32 v85, v110, v226, v85 op_sel:[1,0,0] op_sel_hi:[1,0,0]
    v_fma_mix_f32 v86, v111, v226, v86 op_sel:[0,0,0] op_sel_hi:[1,0,0]
    v_fma_mix_f32 v87, v111, v226, v87 op_sel:[1,0,0] op_sel_hi:[1,0,0]
    v_fma_mix_f32 v64, v112, v228, v64 op_sel:[0,0,0] op_sel_hi:[1,0,0]
    v_fma_mix_f32 v65, v112, v228, v65 op_sel:[1,0,0] op_sel_hi:[1,0,0]
    v_fma_mix_f32 v66, v113, v228, v66 op_sel:[0,0,0] op_sel_hi:[1,0,0]
    v_fma_mix_f32 v67, v113, v228, v67 op_sel:[1,0,0] op_sel_hi:[1,0,0]
    v_fma_mix_f32 v68, v114, v228, v68 op_sel:[0,0,0] op_sel_hi:[1,0,0]
    v_fma_mix_f32 v69, v114, v228, v69 op_sel:[1,0,0] op_sel_hi:[1,0,0]
    v_fma_mix_f32 v70, v115, v228, v70 op_sel:[0,0,0] op_sel_hi:[1,0,0]
    v_fma_mix_f32 v71, v115, v228, v71 op_sel:[1,0,0] op_sel_hi:[1,0,0]
    v_fma_mix_f32 v72, v116, v228, v72 op_sel:[0,0,0] op_sel_hi:[1,0,0]
    v_fma_mix_f32 v73, v116, v228, v73 op_sel:[1,0,0] op_sel_hi:[1,0,0]
    v_fma_mix_f32 v74, v117, v228, v74 op_sel:[0,0,0] op_sel_hi:[1,0,0]
    v_fma_mix_f32 v75, v117, v228, v75 op_sel:[1,0,0] op_sel_hi:[1,0,0]
    v_fma_mix_f32 v76, v118, v228, v76 op_sel:[0,0,0] op_sel_hi:[1,0,0]
    v_fma_mix_f32 v77, v118, v228, v77 op_sel:[1,0,0] op_sel_hi:[1,0,0]
    v_fma_mix_f32 v78, v119, v228, v78 op_sel:[0,0,0] op_sel_hi:[1,0,0]
    v_fma_mix_f32 v79, v119, v228, v79 op_sel:[1,0,0] op_sel_hi:[1,0,0]
    v_fma_mix_f32 v80, v120, v228, v80 op_sel:[0,0,0] op_sel_hi:[1,0,0]
    v_fma_mix_f32 v81, v120, v228, v81 op_sel:[1,0,0] op_sel_hi:[1,0,0]
    v_fma_mix_f32 v82, v121, v228, v82 op_sel:[0,0,0] op_sel_hi:[1,0,0]
    v_cvt_pk_bf16_f32 v208, v64, v65
    v_cvt_pk_bf16_f32 v209, v66, v67
    ds_write_b64 v52, v[208:209]
    v_fma_mix_f32 v83, v121, v228, v83 op_sel:[1,0,0] op_sel_hi:[1,0,0]
    v_cvt_pk_bf16_f32 v210, v68, v69
    v_cvt_pk_bf16_f32 v211, v70, v71
    ds_write_b64 v53, v[210:211]
    v_fma_mix_f32 v84, v122, v228, v84 op_sel:[0,0,0] op_sel_hi:[1,0,0]
    v_cvt_pk_bf16_f32 v212, v72, v73
    v_cvt_pk_bf16_f32 v213, v74, v75
    ds_write_b64 v54, v[212:213]
    v_fma_mix_f32 v85, v122, v228, v85 op_sel:[1,0,0] op_sel_hi:[1,0,0]
    v_cvt_pk_bf16_f32 v214, v76, v77
    v_cvt_pk_bf16_f32 v215, v78, v79
    ds_write_b64 v55, v[214:215]
    v_fma_mix_f32 v86, v123, v228, v86 op_sel:[0,0,0] op_sel_hi:[1,0,0]
    v_cvt_pk_bf16_f32 v216, v80, v81
    v_cvt_pk_bf16_f32 v217, v82, v83
    ds_write_b64 v56, v[216:217]
    v_fma_mix_f32 v87, v123, v228, v87 op_sel:[1,0,0] op_sel_hi:[1,0,0]
    v_cvt_pk_bf16_f32 v218, v84, v85
    v_cvt_pk_bf16_f32 v219, v86, v87
    ds_write_b64 v57, v[218:219]
    s_waitcnt lgkmcnt(0)
    s_barrier
    ds_read_b128 a[0:3], v40 offset:12288
    ds_read_b128 a[24:27], v42 offset:12288
    ds_read_b128 a[4:7], v41 offset:12288
    ds_read_b128 a[28:31], v43 offset:12288
    ds_read_b128 a[8:11], v40 offset:12416
    ds_read_b128 a[32:35], v42 offset:12416
    ds_read_b128 a[12:15], v41 offset:12416
    ds_read_b128 a[36:39], v43 offset:12416
    ds_read_b128 a[16:19], v40 offset:12544
    s_waitcnt lgkmcnt(8)
    s_waitcnt vmcnt(17)
    v_mfma_f32_16x16x32_bf16 v[4:7], a[184:187], a[0:3], v[4:7]
    ds_read_b128 a[40:43], v42 offset:12544
    s_waitcnt lgkmcnt(8)
    v_mfma_f32_16x16x32_bf16 v[8:11], a[184:187], a[24:27], v[8:11]
    ds_read_b128 a[20:23], v41 offset:12544
    s_waitcnt lgkmcnt(8)
    s_waitcnt vmcnt(16)
    v_mfma_f32_16x16x32_bf16 v[4:7], a[188:191], a[4:7], v[4:7]
    ds_read_b128 a[44:47], v43 offset:12544
    s_waitcnt lgkmcnt(8)
    v_mfma_f32_16x16x32_bf16 v[8:11], a[188:191], a[28:31], v[8:11]
    s_waitcnt lgkmcnt(7)
    s_waitcnt vmcnt(15)
    v_mfma_f32_16x16x32_bf16 v[4:7], a[192:195], a[8:11], v[4:7]
    s_waitcnt lgkmcnt(6)
    v_mfma_f32_16x16x32_bf16 v[8:11], a[192:195], a[32:35], v[8:11]
    s_waitcnt lgkmcnt(5)
    s_waitcnt vmcnt(14)
    v_mfma_f32_16x16x32_bf16 v[4:7], a[196:199], a[12:15], v[4:7]
    s_waitcnt lgkmcnt(4)
    v_mfma_f32_16x16x32_bf16 v[8:11], a[196:199], a[36:39], v[8:11]
    s_waitcnt lgkmcnt(3)
    s_waitcnt vmcnt(13)
    v_mfma_f32_16x16x32_bf16 v[4:7], a[200:203], a[16:19], v[4:7]
    s_waitcnt lgkmcnt(2)
    v_mfma_f32_16x16x32_bf16 v[8:11], a[200:203], a[40:43], v[8:11]
    s_waitcnt lgkmcnt(1)
    s_waitcnt vmcnt(12)
    v_mfma_f32_16x16x32_bf16 v[4:7], a[204:207], a[20:23], v[4:7]
    s_waitcnt lgkmcnt(0)
    v_mfma_f32_16x16x32_bf16 v[8:11], a[204:207], a[44:47], v[8:11]
    s_waitcnt vmcnt(11)
    v_mfma_f32_16x16x32_bf16 v[12:15], a[208:211], a[0:3], v[12:15]
    v_mfma_f32_16x16x32_bf16 v[16:19], a[208:211], a[24:27], v[16:19]
    s_waitcnt vmcnt(10)
    v_mfma_f32_16x16x32_bf16 v[12:15], a[212:215], a[4:7], v[12:15]
    v_mfma_f32_16x16x32_bf16 v[16:19], a[212:215], a[28:31], v[16:19]
    s_waitcnt vmcnt(9)
    v_mfma_f32_16x16x32_bf16 v[12:15], a[216:219], a[8:11], v[12:15]
    v_cvt_pk_bf16_f32 v176, v4, v5
    v_mfma_f32_16x16x32_bf16 v[16:19], a[216:219], a[32:35], v[16:19]
    v_cvt_pk_bf16_f32 v177, v6, v7
    v_cvt_pk_bf16_f32 v178, v8, v9
    s_waitcnt vmcnt(8)
    v_mfma_f32_16x16x32_bf16 v[12:15], a[220:223], a[12:15], v[12:15]
    ds_write_b64 v34, v[176:177]
    v_cvt_pk_bf16_f32 v179, v10, v11
    v_mfma_f32_16x16x32_bf16 v[16:19], a[220:223], a[36:39], v[16:19]
    ds_write_b64 v35, v[178:179]
    s_waitcnt vmcnt(7)
    v_mfma_f32_16x16x32_bf16 v[12:15], a[224:227], a[16:19], v[12:15]
    v_mfma_f32_16x16x32_bf16 v[16:19], a[224:227], a[40:43], v[16:19]
    s_waitcnt vmcnt(6)
    v_mfma_f32_16x16x32_bf16 v[12:15], a[228:231], a[20:23], v[12:15]
    v_mfma_f32_16x16x32_bf16 v[16:19], a[228:231], a[44:47], v[16:19]
    s_waitcnt vmcnt(5)
    v_mfma_f32_16x16x32_bf16 v[20:23], a[232:235], a[0:3], v[20:23]
    v_mfma_f32_16x16x32_bf16 v[24:27], a[232:235], a[24:27], v[24:27]
    s_waitcnt vmcnt(4)
    v_mfma_f32_16x16x32_bf16 v[20:23], a[236:239], a[4:7], v[20:23]
    v_mfma_f32_16x16x32_bf16 v[24:27], a[236:239], a[28:31], v[24:27]
    s_waitcnt vmcnt(3)
    v_mfma_f32_16x16x32_bf16 v[20:23], a[240:243], a[8:11], v[20:23]
    v_mfma_f32_16x16x32_bf16 v[24:27], a[240:243], a[32:35], v[24:27]
    v_cvt_pk_bf16_f32 v180, v12, v13
    s_waitcnt vmcnt(2)
    v_mfma_f32_16x16x32_bf16 v[20:23], a[244:247], a[12:15], v[20:23]
    v_cvt_pk_bf16_f32 v181, v14, v15
    v_cvt_pk_bf16_f32 v182, v16, v17
    v_mfma_f32_16x16x32_bf16 v[24:27], a[244:247], a[36:39], v[24:27]
    ds_write_b64 v36, v[180:181]
    v_cvt_pk_bf16_f32 v183, v18, v19
    s_waitcnt vmcnt(1)
    v_mfma_f32_16x16x32_bf16 v[20:23], a[248:251], a[16:19], v[20:23]
    ds_write_b64 v37, v[182:183]
    s_waitcnt vmcnt(0)
    v_mfma_f32_16x16x32_bf16 v[20:23], a[252:255], a[20:23], v[20:23]
    v_mfma_f32_16x16x32_bf16 v[24:27], a[248:251], a[40:43], v[24:27]
    v_mfma_f32_16x16x32_bf16 v[24:27], a[252:255], a[44:47], v[24:27]
    s_nop 5
    v_cvt_pk_bf16_f32 v184, v20, v21
    v_cvt_pk_bf16_f32 v185, v22, v23
    ds_write_b64 v38, v[184:185]
    v_cvt_pk_bf16_f32 v186, v24, v25
    v_cvt_pk_bf16_f32 v187, v26, v27
    ds_write_b64 v39, v[186:187]
    s_waitcnt lgkmcnt(0)
    s_barrier
    ds_read_b128 v[64:67], v59 offset:0
    ds_read_b128 v[68:71], v59 offset:128
    ds_read_b128 v[72:75], v59 offset:256
    s_waitcnt lgkmcnt(2)
    buffer_store_dwordx4 v[64:67], v58, s[20:23], 0 offen offset:0 sc1
    s_waitcnt lgkmcnt(1)
    buffer_store_dwordx4 v[68:71], v58, s[20:23], 0 offen offset:128 sc1
    s_waitcnt lgkmcnt(0)
    buffer_store_dwordx4 v[72:75], v58, s[20:23], 0 offen offset:256 sc1
L_fin:
L_end:
    s_endpgm
L_fold:
    s_load_dwordx2 s[64:65], s[0:1], 24
    s_load_dwordx2 s[68:69], s[0:1], 32
    s_mov_b32 s66, 221184
    s_mov_b32 s67, 0x00020000
    s_mov_b32 s70, 73728
    s_mov_b32 s71, 0x00020000
    s_sub_u32 s32, s2, 184
    s_cmp_ge_u32 s32, 18
    s_cselect_b32 s34, 18, 0
    s_cselect_b32 s35, 768, 0
    s_sub_u32 s33, s32, s34
    s_mul_i32 s36, s33, 86
    s_lshr_b32 s36, s36, 8
    s_mul_i32 s37, s36, 3
    s_sub_u32 s37, s33, s37
    s_lshl_b32 s38, s3, 3
    s_mul_i32 s63, s3, 3072
    v_add_u32 v8, 0, v1
    v_mul_u32_u24 v9, 683, v8
    v_lshrrev_b32 v9, 14, v9
    v_add_u32 v10, s38, v9
    v_lshrrev_b32 v12, 3, v10
    v_xor_b32 v12, v12, v10
    v_and_b32 v12, 14, v12
    v_lshlrev_b32 v11, 3, v12
    v_xor_b32 v11, v32, v11
    v_mul_u32_u24 v9, 768, v9
    v_add_u32 v9, v9, v11
    s_mul_i32 s39, s38, 1152
    v_add_u32 v16, s39, v9
    v_add_u32 v8, 64, v1
    v_mul_u32_u24 v9, 683, v8
    v_lshrrev_b32 v9, 14, v9
    v_add_u32 v10, s38, v9
    v_lshrrev_b32 v12, 3, v10
    v_xor_b32 v12, v12, v10
    v_and_b32 v12, 14, v12
    v_lshlrev_b32 v11, 3, v12
    v_xor_b32 v11, v32, v11
    v_mul_u32_u24 v9, 768, v9
    v_add_u32 v9, v9, v11
    s_mul_i32 s39, s38, 1152
    v_add_u32 v17, s39, v9
    v_add_u32 v8, 128, v1
    v_mul_u32_u24 v9, 683, v8
    v_lshrrev_b32 v9, 14, v9
    v_add_u32 v10, s38, v9
    v_lshrrev_b32 v12, 3, v10
    v_xor_b32 v12, v12, v10
    v_and_b32 v12, 14, v12
    v_lshlrev_b32 v11, 3, v12
    v_xor_b32 v11, v32, v11
    v_mul_u32_u24 v9, 768, v9
    v_add_u32 v9, v9, v11
    s_mul_i32 s39, s38, 1152
    v_add_u32 v18, s39, v9
    v_lshrrev_b32 v8, 3, v1
    v_mul_u32_u24 v8, 384, v8
    v_and_b32 v9, 7, v1
    v_bfe_u32 v10, v1, 4, 1
    v_lshlrev_b32 v10, 1, v10
    v_xor_b32 v9, v9, v10
    v_lshl_add_u32 v19, v9, 4, v8
    v_xor_b32 v20, 64, v19
    s_mul_i32 s39, s36, 36864
    s_add_u32 s39, s39, s35
    s_mov_b32 m0, s63
    s_waitcnt lgkmcnt(0)
    buffer_load_dwordx4 v16, s[64:67], s39 offen offset:0 nt lds
    buffer_load_dwordx4 v17, s[64:67], s39 offen offset:1024 nt lds
    buffer_load_dwordx4 v18, s[64:67], s39 offen offset:2048 nt lds
    s_cmp_ge_u32 s32, 18
    s_cbranch_scc1 L_fb_21
    s_mul_i32 s39, s37, 73728
    s_add_u32 s39, s39, 384
    s_add_u32 m0, s63, 12288
    s_nop 0
    buffer_load_dwordx4 v16, s[64:67], s39 offen offset:0 nt lds
    buffer_load_dwordx4 v17, s[64:67], s39 offen offset:1024 nt lds
    buffer_load_dwordx4 v18, s[64:67], s39 offen offset:2048 nt lds
    s_add_u32 m0, s63, 24576
    s_add_u32 s39, s39, 36864
    buffer_load_dwordx4 v16, s[64:67], s39 offen offset:0 nt lds
    buffer_load_dwordx4 v17, s[64:67], s39 offen offset:1024 nt lds
    buffer_load_dwordx4 v18, s[64:67], s39 offen offset:2048 nt lds
    s_branch L_fj_22
L_fb_21:
    s_mul_i32 s39, s3, 18432
    s_lshl_b32 s40, s37, 7
    s_add_u32 s39, s39, s40
    s_mul_i32 s40, s3, 6144
    s_add_u32 m0, s40, 12288
    s_nop 0
    buffer_load_dwordx4 v19, s[68:71], s39 offen nt lds
    s_add_u32 s39, s39, 3072
    s_add_u32 m0, s40, 13312
    s_nop 0
    buffer_load_dwordx4 v20, s[68:71], s39 offen nt lds
    s_add_u32 s39, s39, 3072
    s_add_u32 m0, s40, 14336
    s_nop 0
    buffer_load_dwordx4 v19, s[68:71], s39 offen nt lds
    s_add_u32 s39, s39, 3072
    s_add_u32 m0, s40, 15360
    s_nop 0
    buffer_load_dwordx4 v20, s[68:71], s39 offen nt lds
    s_add_u32 s39, s39, 3072
    s_add_u32 m0, s40, 16384
    s_nop 0
    buffer_load_dwordx4 v19, s[68:71], s39 offen nt lds
    s_add_u32 s39, s39, 3072
    s_add_u32 m0, s40, 17408
    s_nop 0
    buffer_load_dwordx4 v20, s[68:71], s39 offen nt lds
    s_add_u32 s39, s39, 3072
L_fj_22:
    v_mov_b64 v[12:13], 0
    v_mov_b64 v[14:15], 0
    s_mul_i32 s39, s32, 43
    v_add_u32 v10, s39, v0
    v_cmp_gt_u32 vcc, 43, v0
    v_mul_u32_u24 v10, 16, v10
    v_mov_b32 v11, 2147418112
    v_add_u32 v10, 2172928, v10
    v_cndmask_b32 v10, v11, v10, vcc
    buffer_store_dword v12, v10, s[12:15], 0 offen sc1
    v_lshrrev_b32 v8, 2, v2
    v_and_b32 v9, 3, v2
    v_lshl_add_u32 v8, v8, 3, v9
    v_add_u32 v9, 0, v8
    v_lshrrev_b32 v12, 3, v9
    v_xor_b32 v12, v12, v9
    v_and_b32 v12, 14, v12
    v_lshlrev_b32 v11, 3, v12
    v_lshlrev_b32 v12, 4, v3
    v_mul_u32_u24 v9, 384, v9
    v_xad_u32 v40, v12, v11, v9
    v_xor_b32 v41, 64, v40
    v_add_u32 v9, 4, v8
    v_lshrrev_b32 v12, 3, v9
    v_xor_b32 v12, v12, v9
    v_and_b32 v12, 14, v12
    v_lshlrev_b32 v11, 3, v12
    v_lshlrev_b32 v12, 4, v3
    v_mul_u32_u24 v9, 384, v9
    v_xad_u32 v42, v12, v11, v9
    v_xor_b32 v43, 64, v42
    s_and_b32 s39, s3, 1
    s_lshl_b32 s39, s39, 4
    v_add_u32 v9, s39, v2
    v_lshrrev_b32 v12, 3, v9
    v_xor_b32 v12, v12, v9
    v_and_b32 v12, 14, v12
    v_lshlrev_b32 v11, 3, v12
    v_lshlrev_b32 v12, 4, v3
    v_mul_u32_u24 v9, 384, v9
    s_lshr_b32 s39, s3, 1
    s_mul_i32 s39, s39, 12288
    s_add_u32 s39, s39, 12288
    v_add_u32 v9, s39, v9
    v_xad_u32 v44, v12, v11, v9
    v_xor_b32 v45, 64, v44
    v_lshrrev_b32 v8, 2, v2
    v_lshl_add_u32 v8, v3, 3, v8
    v_lshlrev_b32 v8, 7, v8
    v_lshrrev_b32 v9, 3, v2
    v_and_b32 v11, 1, v3
    v_lshl_add_u32 v9, v11, 1, v9
    v_xor_b32 v9, s3, v9
    v_lshl_add_u32 v8, v9, 5, v8
    v_and_b32 v9, 3, v2
    v_lshl_add_u32 v8, v9, 3, v8
    v_add_u32 v46, 12288, v8
    s_lshl_b32 s38, s37, 2
    s_add_u32 s38, s38, s3
    s_mul_i32 s38, s38, 6144
    s_lshl_b32 s39, s36, 10
    s_add_u32 s38, s38, s39
    s_waitcnt vmcnt(1)
    s_barrier
    ds_read_b128 v[64:67], v40 offset:0
    ds_read_b128 v[88:91], v42 offset:0
    ds_read_b128 v[68:71], v41 offset:0
    ds_read_b128 v[92:95], v43 offset:0
    ds_read_b128 v[72:75], v40 offset:128
    ds_read_b128 v[96:99], v42 offset:128
    ds_read_b128 v[76:79], v41 offset:128
    ds_read_b128 v[100:103], v43 offset:128
    ds_read_b128 v[80:83], v40 offset:256
    ds_read_b128 v[104:107], v42 offset:256
    ds_read_b128 v[84:87], v41 offset:256
    ds_read_b128 v[108:111], v43 offset:256
    s_cmp_ge_u32 s32, 18
    s_cbranch_scc1 L_fb_23
    ds_read_b128 v[112:115], v44 offset:0
    ds_read_b128 v[116:119], v45 offset:0
    ds_read_b128 v[120:123], v44 offset:128
    ds_read_b128 v[124:127], v45 offset:128
    ds_read_b128 v[128:131], v44 offset:256
    ds_read_b128 v[132:135], v45 offset:256
    s_add_u32 s38, s38, 2025472
    s_mov_b32 s40, 0x3dd53b95
    s_waitcnt lgkmcnt(0)
    s_branch L_fj_24
L_fb_23:
    ds_read_b64_tr_b16 v[112:113], v46 offset:0
    ds_read_b64_tr_b16 v[114:115], v46 offset:512
    ds_read_b64_tr_b16 v[116:117], v46 offset:4096
    ds_read_b64_tr_b16 v[118:119], v46 offset:4608
    ds_read_b64_tr_b16 v[120:121], v46 offset:8192
    ds_read_b64_tr_b16 v[122:123], v46 offset:8704
    ds_read_b64_tr_b16 v[124:125], v46 offset:12288
    ds_read_b64_tr_b16 v[126:127], v46 offset:12800
    ds_read_b64_tr_b16 v[128:129], v46 offset:16384
    ds_read_b64_tr_b16 v[130:131], v46 offset:16896
    ds_read_b64_tr_b16 v[132:133], v46 offset:20480
    ds_read_b64_tr_b16 v[134:135], v46 offset:20992
    s_add_u32 s38, s38, 2099200
    s_mov_b32 s40, 1.0
    s_waitcnt lgkmcnt(0)
L_fj_24:
    v_mfma_f32_16x16x32_bf16 v[24:27], v[64:67], v[112:115], 0
    v_mfma_f32_16x16x32_bf16 v[28:31], v[88:91], v[112:115], 0
    v_mfma_f32_16x16x32_bf16 v[24:27], v[68:71], v[116:119], v[24:27]
    v_mfma_f32_16x16x32_bf16 v[28:31], v[92:95], v[116:119], v[28:31]
    v_mfma_f32_16x16x32_bf16 v[24:27], v[72:75], v[120:123], v[24:27]
    v_mfma_f32_16x16x32_bf16 v[28:31], v[96:99], v[120:123], v[28:31]
    v_mfma_f32_16x16x32_bf16 v[24:27], v[76:79], v[124:127], v[24:27]
    v_mfma_f32_16x16x32_bf16 v[28:31], v[100:103], v[124:127], v[28:31]
    v_mfma_f32_16x16x32_bf16 v[24:27], v[80:83], v[128:131], v[24:27]
    v_mfma_f32_16x16x32_bf16 v[28:31], v[104:107], v[128:131], v[28:31]
    v_mfma_f32_16x16x32_bf16 v[24:27], v[84:87], v[132:135], v[24:27]
    v_mfma_f32_16x16x32_bf16 v[28:31], v[108:111], v[132:135], v[28:31]
    s_nop 6
    v_mul_f32 v24, s40, v24
    v_mul_f32 v25, s40, v25
    v_mul_f32 v26, s40, v26
    v_mul_f32 v27, s40, v27
    v_mul_f32 v28, s40, v28
    v_mul_f32 v29, s40, v29
    v_mul_f32 v30, s40, v30
    v_mul_f32 v31, s40, v31
    v_cvt_pk_bf16_f32 v48, v24, v25
    v_cvt_pk_bf16_f32 v49, v26, v27
    v_cvt_pk_bf16_f32 v50, v28, v29
    v_cvt_pk_bf16_f32 v51, v30, v31
    buffer_store_dwordx4 v[48:51], v32, s[12:15], s38 offen sc1
    v_cmp_eq_u32 vcc, 0, v0
    v_mov_b32 v10, 2147418112
    v_mov_b32 v11, 1
    v_cndmask_b32 v10, v10, v0, vcc
    s_waitcnt vmcnt(0)
    s_barrier
    buffer_atomic_add v11, v10, s[24:27], 0 offen sc1
    s_endpgm
L_hot_end:
L_fcw:
    s_mov_b32 s33, 0
L_fcl:
    buffer_load_dword v156, off, s[24:27], 0 sc1
    s_add_u32 s33, s33, 1
    s_cmp_gt_u32 s33, 262144
    s_waitcnt vmcnt(0)
    s_cbranch_scc1 L_fcb
    v_cmp_gt_u32 vcc, 36, v156
    s_cbranch_vccnz L_fcl
    s_branch L_fcb
L_resc_9:
    s_nop 15
    s_nop 7
    v_max3_f32 v237, v160, v161, v162
    v_max3_f32 v237, v237, v163, v164
    v_max3_f32 v237, v237, v165, v166
    v_max3_f32 v237, v237, v167, v168
    v_max3_f32 v237, v237, v169, v170
    v_max3_f32 v237, v237, v171, v172
    v_max3_f32 v237, v237, v173, v174
    v_max_f32 v237, v237, v175
    v_mov_b32 v235, v237
    s_nop 1
    v_permlane32_swap_b32 v235, v237
    v_max_f32 v237, v237, v235
    v_add_f32 v234, v234, v237
    v_exp_f32 v238, -v237
    v_sub_f32 v192, 0, v234
    v_sub_f32 v193, 0, v234
    v_sub_f32 v194, 0, v234
    v_sub_f32 v195, 0, v234
    v_sub_f32 v196, 0, v234
    v_sub_f32 v197, 0, v234
    v_sub_f32 v198, 0, v234
    v_sub_f32 v199, 0, v234
    v_sub_f32 v200, 0, v234
    v_sub_f32 v201, 0, v234
    v_sub_f32 v202, 0, v234
    v_sub_f32 v203, 0, v234
    v_sub_f32 v204, 0, v234
    v_sub_f32 v205, 0, v234
    v_sub_f32 v206, 0, v234
    v_sub_f32 v207, 0, v234
    v_sub_f32 v160, v160, v237
    v_sub_f32 v161, v161, v237
    v_sub_f32 v162, v162, v237
    v_sub_f32 v163, v163, v237
    v_sub_f32 v164, v164, v237
    v_sub_f32 v165, v165, v237
    v_sub_f32 v166, v166, v237
    v_sub_f32 v167, v167, v237
    v_sub_f32 v168, v168, v237
    v_sub_f32 v169, v169, v237
    v_sub_f32 v170, v170, v237
    v_sub_f32 v171, v171, v237
    v_sub_f32 v172, v172, v237
    v_sub_f32 v173, v173, v237
    v_sub_f32 v174, v174, v237
    v_sub_f32 v175, v175, v237
    v_sub_f32 v176, v176, v237
    v_sub_f32 v177, v177, v237
    v_sub_f32 v178, v178, v237
    v_sub_f32 v179, v179, v237
    v_sub_f32 v180, v180, v237
    v_sub_f32 v181, v181, v237
    v_sub_f32 v182, v182, v237
    v_sub_f32 v183, v183, v237
    v_sub_f32 v184, v184, v237
    v_sub_f32 v185, v185, v237
    v_sub_f32 v186, v186, v237
    v_sub_f32 v187, v187, v237
    v_sub_f32 v188, v188, v237
    v_sub_f32 v189, v189, v237
    v_sub_f32 v190, v190, v237
    v_sub_f32 v191, v191, v237
    v_exp_f32 v224, v160
    v_exp_f32 v225, v161
    v_exp_f32 v226, v162
    v_add_f32 v233, v224, v225
    v_cvt_pk_bf16_f32 v208, v224, v225
    v_exp_f32 v227, v163
    v_exp_f32 v228, v164
    v_add_f32 v233, v233, v226
    v_add_f32 v233, v233, v227
    v_cvt_pk_bf16_f32 v209, v226, v227
    v_exp_f32 v229, v165
    v_exp_f32 v230, v166
    v_add_f32 v233, v233, v228
    v_add_f32 v233, v233, v229
    v_cvt_pk_bf16_f32 v210, v228, v229
    v_exp_f32 v231, v167
    v_exp_f32 v224, v168
    v_add_f32 v233, v233, v230
    v_add_f32 v233, v233, v231
    v_cvt_pk_bf16_f32 v211, v230, v231
    v_exp_f32 v225, v169
    v_exp_f32 v226, v170
    v_add_f32 v233, v233, v224
    v_add_f32 v233, v233, v225
    v_cvt_pk_bf16_f32 v212, v224, v225
    v_exp_f32 v227, v171
    v_exp_f32 v228, v172
    v_add_f32 v233, v233, v226
    v_add_f32 v233, v233, v227
    v_cvt_pk_bf16_f32 v213, v226, v227
    v_exp_f32 v229, v173
    v_exp_f32 v230, v174
    v_add_f32 v233, v233, v228
    v_add_f32 v233, v233, v229
    v_cvt_pk_bf16_f32 v214, v228, v229
    v_exp_f32 v231, v175
    v_add_f32 v233, v233, v230
    v_add_f32 v233, v233, v231
    v_cvt_pk_bf16_f32 v215, v230, v231
    s_nop 1
    s_branch L_rescb_10
L_resc_11:
    s_nop 15
    s_nop 7
    v_max3_f32 v237, v176, v177, v178
    v_max3_f32 v237, v237, v179, v180
    v_max3_f32 v237, v237, v181, v182
    v_max3_f32 v237, v237, v183, v184
    v_max3_f32 v237, v237, v185, v186
    v_max3_f32 v237, v237, v187, v188
    v_max3_f32 v237, v237, v189, v190
    v_max_f32 v237, v237, v191
    v_mov_b32 v235, v237
    s_nop 1
    v_permlane32_swap_b32 v235, v237
    v_max_f32 v237, v237, v235
    v_max_f32 v237, 0, v237
    v_add_f32 v234, v234, v237
    v_exp_f32 v238, -v237
    v_sub_f32 v192, 0, v234
    v_sub_f32 v193, 0, v234
    v_sub_f32 v194, 0, v234
    v_sub_f32 v195, 0, v234
    v_sub_f32 v196, 0, v234
    v_sub_f32 v197, 0, v234
    v_sub_f32 v198, 0, v234
    v_sub_f32 v199, 0, v234
    v_sub_f32 v200, 0, v234
    v_sub_f32 v201, 0, v234
    v_sub_f32 v202, 0, v234
    v_sub_f32 v203, 0, v234
    v_sub_f32 v204, 0, v234
    v_sub_f32 v205, 0, v234
    v_sub_f32 v206, 0, v234
    v_sub_f32 v207, 0, v234
    v_sub_f32 v176, v176, v237
    v_sub_f32 v177, v177, v237
    v_sub_f32 v178, v178, v237
    v_sub_f32 v179, v179, v237
    v_sub_f32 v180, v180, v237
    v_sub_f32 v181, v181, v237
    v_sub_f32 v182, v182, v237
    v_sub_f32 v183, v183, v237
    v_sub_f32 v184, v184, v237
    v_sub_f32 v185, v185, v237
    v_sub_f32 v186, v186, v237
    v_sub_f32 v187, v187, v237
    v_sub_f32 v188, v188, v237
    v_sub_f32 v189, v189, v237
    v_sub_f32 v190, v190, v237
    v_sub_f32 v191, v191, v237
    v_sub_f32 v160, v160, v237
    v_sub_f32 v161, v161, v237
    v_sub_f32 v162, v162, v237
    v_sub_f32 v163, v163, v237
    v_sub_f32 v164, v164, v237
    v_sub_f32 v165, v165, v237
    v_sub_f32 v166, v166, v237
    v_sub_f32 v167, v167, v237
    v_sub_f32 v168, v168, v237
    v_sub_f32 v169, v169, v237
    v_sub_f32 v170, v170, v237
    v_sub_f32 v171, v171, v237
    v_sub_f32 v172, v172, v237
    v_sub_f32 v173, v173, v237
    v_sub_f32 v174, v174, v237
    v_sub_f32 v175, v175, v237
    v_mul_f32 v232, v232, v238
    v_mul_f32 v64, v64, v238
    v_mul_f32 v65, v65, v238
    v_mul_f32 v66, v66, v238
    v_mul_f32 v67, v67, v238
    v_mul_f32 v68, v68, v238
    v_mul_f32 v69, v69, v238
    v_mul_f32 v70, v70, v238
    v_mul_f32 v71, v71, v238
    v_mul_f32 v72, v72, v238
    v_mul_f32 v73, v73, v238
    v_mul_f32 v74, v74, v238
    v_mul_f32 v75, v75, v238
    v_mul_f32 v76, v76, v238
    v_mul_f32 v77, v77, v238
    v_mul_f32 v78, v78, v238
    v_mul_f32 v79, v79, v238
    v_mul_f32 v80, v80, v238
    v_mul_f32 v81, v81, v238
    v_mul_f32 v82, v82, v238
    v_mul_f32 v83, v83, v238
    v_mul_f32 v84, v84, v238
    v_mul_f32 v85, v85, v238
    v_mul_f32 v86, v86, v238
    v_mul_f32 v87, v87, v238
    v_mul_f32 v88, v88, v238
    v_mul_f32 v89, v89, v238
    v_mul_f32 v90, v90, v238
    v_mul_f32 v91, v91, v238
    v_mul_f32 v92, v92, v238
    v_mul_f32 v93, v93, v238
    v_mul_f32 v94, v94, v238
    v_mul_f32 v95, v95, v238
    v_mul_f32 v96, v96, v238
    v_mul_f32 v97, v97, v238
    v_mul_f32 v98, v98, v238
    v_mul_f32 v99, v99, v238
    v_mul_f32 v100, v100, v238
    v_mul_f32 v101, v101, v238
    v_mul_f32 v102, v102, v238
    v_mul_f32 v103, v103, v238
    v_mul_f32 v104, v104, v238
    v_mul_f32 v105, v105, v238
    v_mul_f32 v106, v106, v238
    v_mul_f32 v107, v107, v238
    v_mul_f32 v108, v108, v238
    v_mul_f32 v109, v109, v238
    v_mul_f32 v110, v110, v238
    v_mul_f32 v111, v111, v238
    v_mul_f32 v112, v112, v238
    v_mul_f32 v113, v113, v238
    v_mul_f32 v114, v114, v238
    v_mul_f32 v115, v115, v238
    v_mul_f32 v116, v116, v238
    v_mul_f32 v117, v117, v238
    v_mul_f32 v118, v118, v238
    v_mul_f32 v119, v119, v238
    v_mul_f32 v120, v120, v238
    v_mul_f32 v121, v121, v238
    v_mul_f32 v122, v122, v238
    v_mul_f32 v123, v123, v238
    v_mul_f32 v124, v124, v238
    v_mul_f32 v125, v125, v238
    v_mul_f32 v126, v126, v238
    v_mul_f32 v127, v127, v238
    v_mul_f32 v128, v128, v238
    v_mul_f32 v129, v129, v238
    v_mul_f32 v130, v130, v238
    v_mul_f32 v131, v131, v238
    v_mul_f32 v132, v132, v238
    v_mul_f32 v133, v133, v238
    v_mul_f32 v134, v134, v238
    v_mul_f32 v135, v135, v238
    v_mul_f32 v136, v136, v238
    v_mul_f32 v137, v137, v238
    v_mul_f32 v138, v138, v238
    v_mul_f32 v139, v139, v238
    v_mul_f32 v140, v140, v238
    v_mul_f32 v141, v141, v238
    v_mul_f32 v142, v142, v238
    v_mul_f32 v143, v143, v238
    v_mul_f32 v144, v144, v238
    v_mul_f32 v145, v145, v238
    v_mul_f32 v146, v146, v238
    v_mul_f32 v147, v147, v238
    v_mul_f32 v148, v148, v238
    v_mul_f32 v149, v149, v238
    v_mul_f32 v150, v150, v238
    v_mul_f32 v151, v151, v238
    v_mul_f32 v152, v152, v238
    v_mul_f32 v153, v153, v238
    v_mul_f32 v154, v154, v238
    v_mul_f32 v155, v155, v238
    v_mul_f32 v156, v156, v238
    v_mul_f32 v157, v157, v238
    v_mul_f32 v158, v158, v238
    v_mul_f32 v159, v159, v238
    v_exp_f32 v224, v176
    v_exp_f32 v225, v177
    v_exp_f32 v226, v178
    v_add_f32 v233, v224, v225
    v_cvt_pk_bf16_f32 v216, v224, v225
    v_exp_f32 v227, v179
    v_exp_f32 v228, v180
    v_add_f32 v233, v233, v226
    v_add_f32 v233, v233, v227
    v_cvt_pk_bf16_f32 v217, v226, v227
    v_exp_f32 v229, v181
    v_exp_f32 v230, v182
    v_add_f32 v233, v233, v228
    v_add_f32 v233, v233, v229
    v_cvt_pk_bf16_f32 v218, v228, v229
    v_exp_f32 v231, v183
    v_exp_f32 v224, v184
    v_add_f32 v233, v233, v230
    v_add_f32 v233, v233, v231
    v_cvt_pk_bf16_f32 v219, v230, v231
    v_exp_f32 v225, v185
    v_exp_f32 v226, v186
    v_add_f32 v233, v233, v224
    v_add_f32 v233, v233, v225
    v_cvt_pk_bf16_f32 v220, v224, v225
    v_exp_f32 v227, v187
    v_exp_f32 v228, v188
    v_add_f32 v233, v233, v226
    v_add_f32 v233, v233, v227
    v_cvt_pk_bf16_f32 v221, v226, v227
    v_exp_f32 v229, v189
    v_exp_f32 v230, v190
    v_add_f32 v233, v233, v228
    v_add_f32 v233, v233, v229
    v_cvt_pk_bf16_f32 v222, v228, v229
    v_exp_f32 v231, v191
    v_add_f32 v233, v233, v230
    v_add_f32 v233, v233, v231
    v_cvt_pk_bf16_f32 v223, v230, v231
    s_nop 1
    s_branch L_rescb_12
L_resc_13:
    s_nop 15
    s_nop 7
    v_max3_f32 v237, v160, v161, v162
    v_max3_f32 v237, v237, v163, v164
    v_max3_f32 v237, v237, v165, v166
    v_max3_f32 v237, v237, v167, v168
    v_max3_f32 v237, v237, v169, v170
    v_max3_f32 v237, v237, v171, v172
    v_max3_f32 v237, v237, v173, v174
    v_max_f32 v237, v237, v175
    v_mov_b32 v235, v237
    s_nop 1
    v_permlane32_swap_b32 v235, v237
    v_max_f32 v237, v237, v235
    v_max_f32 v237, 0, v237
    v_add_f32 v234, v234, v237
    v_exp_f32 v238, -v237
    v_sub_f32 v192, 0, v234
    v_sub_f32 v193, 0, v234
    v_sub_f32 v194, 0, v234
    v_sub_f32 v195, 0, v234
    v_sub_f32 v196, 0, v234
    v_sub_f32 v197, 0, v234
    v_sub_f32 v198, 0, v234
    v_sub_f32 v199, 0, v234
    v_sub_f32 v200, 0, v234
    v_sub_f32 v201, 0, v234
    v_sub_f32 v202, 0, v234
    v_sub_f32 v203, 0, v234
    v_sub_f32 v204, 0, v234
    v_sub_f32 v205, 0, v234
    v_sub_f32 v206, 0, v234
    v_sub_f32 v207, 0, v234
    v_sub_f32 v160, v160, v237
    v_sub_f32 v161, v161, v237
    v_sub_f32 v162, v162, v237
    v_sub_f32 v163, v163, v237
    v_sub_f32 v164, v164, v237
    v_sub_f32 v165, v165, v237
    v_sub_f32 v166, v166, v237
    v_sub_f32 v167, v167, v237
    v_sub_f32 v168, v168, v237
    v_sub_f32 v169, v169, v237
    v_sub_f32 v170, v170, v237
    v_sub_f32 v171, v171, v237
    v_sub_f32 v172, v172, v237
    v_sub_f32 v173, v173, v237
    v_sub_f32 v174, v174, v237
    v_sub_f32 v175, v175, v237
    v_sub_f32 v176, v176, v237
    v_sub_f32 v177, v177, v237
    v_sub_f32 v178, v178, v237
    v_sub_f32 v179, v179, v237
    v_sub_f32 v180, v180, v237
    v_sub_f32 v181, v181, v237
    v_sub_f32 v182, v182, v237
    v_sub_f32 v183, v183, v237
    v_sub_f32 v184, v184, v237
    v_sub_f32 v185, v185, v237
    v_sub_f32 v186, v186, v237
    v_sub_f32 v187, v187, v237
    v_sub_f32 v188, v188, v237
    v_sub_f32 v189, v189, v237
    v_sub_f32 v190, v190, v237
    v_sub_f32 v191, v191, v237
    v_mul_f32 v232, v232, v238
    v_mul_f32 v64, v64, v238
    v_mul_f32 v65, v65, v238
    v_mul_f32 v66, v66, v238
    v_mul_f32 v67, v67, v238
    v_mul_f32 v68, v68, v238
    v_mul_f32 v69, v69, v238
    v_mul_f32 v70, v70, v238
    v_mul_f32 v71, v71, v238
    v_mul_f32 v72, v72, v238
    v_mul_f32 v73, v73, v238
    v_mul_f32 v74, v74, v238
    v_mul_f32 v75, v75, v238
    v_mul_f32 v76, v76, v238
    v_mul_f32 v77, v77, v238
    v_mul_f32 v78, v78, v238
    v_mul_f32 v79, v79, v238
    v_mul_f32 v80, v80, v238
    v_mul_f32 v81, v81, v238
    v_mul_f32 v82, v82, v238
    v_mul_f32 v83, v83, v238
    v_mul_f32 v84, v84, v238
    v_mul_f32 v85, v85, v238
    v_mul_f32 v86, v86, v238
    v_mul_f32 v87, v87, v238
    v_mul_f32 v88, v88, v238
    v_mul_f32 v89, v89, v238
    v_mul_f32 v90, v90, v238
    v_mul_f32 v91, v91, v238
    v_mul_f32 v92, v92, v238
    v_mul_f32 v93, v93, v238
    v_mul_f32 v94, v94, v238
    v_mul_f32 v95, v95, v238
    v_mul_f32 v96, v96, v238
    v_mul_f32 v97, v97, v238
    v_mul_f32 v98, v98, v238
    v_mul_f32 v99, v99, v238
    v_mul_f32 v100, v100, v238
    v_mul_f32 v101, v101, v238
    v_mul_f32 v102, v102, v238
    v_mul_f32 v103, v103, v238
    v_mul_f32 v104, v104, v238
    v_mul_f32 v105, v105, v238
    v_mul_f32 v106, v106, v238
    v_mul_f32 v107, v107, v238
    v_mul_f32 v108, v108, v238
    v_mul_f32 v109, v109, v238
    v_mul_f32 v110, v110, v238
    v_mul_f32 v111, v111, v238
    v_mul_f32 v112, v112, v238
    v_mul_f32 v113, v113, v238
    v_mul_f32 v114, v114, v238
    v_mul_f32 v115, v115, v238
    v_mul_f32 v116, v116, v238
    v_mul_f32 v117, v117, v238
    v_mul_f32 v118, v118, v238
    v_mul_f32 v119, v119, v238
    v_mul_f32 v120, v120, v238
    v_mul_f32 v121, v121, v238
    v_mul_f32 v122, v122, v238
    v_mul_f32 v123, v123, v238
    v_mul_f32 v124, v124, v238
    v_mul_f32 v125, v125, v238
    v_mul_f32 v126, v126, v238
    v_mul_f32 v127, v127, v238
    v_mul_f32 v128, v128, v238
    v_mul_f32 v129, v129, v238
    v_mul_f32 v130, v130, v238
    v_mul_f32 v131, v131, v238
    v_mul_f32 v132, v132, v238
    v_mul_f32 v133, v133, v238
    v_mul_f32 v134, v134, v238
    v_mul_f32 v135, v135, v238
    v_mul_f32 v136, v136, v238
    v_mul_f32 v137, v137, v238
    v_mul_f32 v138, v138, v238
    v_mul_f32 v139, v139, v238
    v_mul_f32 v140, v140, v238
    v_mul_f32 v141, v141, v238
    v_mul_f32 v142, v142, v238
    v_mul_f32 v143, v143, v238
    v_mul_f32 v144, v144, v238
    v_mul_f32 v145, v145, v238
    v_mul_f32 v146, v146, v238
    v_mul_f32 v147, v147, v238
    v_mul_f32 v148, v148, v238
    v_mul_f32 v149, v149, v238
    v_mul_f32 v150, v150, v238
    v_mul_f32 v151, v151, v238
    v_mul_f32 v152, v152, v238
    v_mul_f32 v153, v153, v238
    v_mul_f32 v154, v154, v238
    v_mul_f32 v155, v155, v238
    v_mul_f32 v156, v156, v238
    v_mul_f32 v157, v157, v238
    v_mul_f32 v158, v158, v238
    v_mul_f32 v159, v159, v238
    v_exp_f32 v224, v160
    v_exp_f32 v225, v161
    v_exp_f32 v226, v162
    v_add_f32 v233, v224, v225
    v_cvt_pk_bf16_f32 v208, v224, v225
    v_exp_f32 v227, v163
    v_exp_f32 v228, v164
    v_add_f32 v233, v233, v226
    v_add_f32 v233, v233, v227
    v_cvt_pk_bf16_f32 v209, v226, v227
    v_exp_f32 v229, v165
    v_exp_f32 v230, v166
    v_add_f32 v233, v233, v228
    v_add_f32 v233, v233, v229
    v_cvt_pk_bf16_f32 v210, v228, v229
    v_exp_f32 v231, v167
    v_exp_f32 v224, v168
    v_add_f32 v233, v233, v230
    v_add_f32 v233, v233, v231
    v_cvt_pk_bf16_f32 v211, v230, v231
    v_exp_f32 v225, v169
    v_exp_f32 v226, v170
    v_add_f32 v233, v233, v224
    v_add_f32 v233, v233, v225
    v_cvt_pk_bf16_f32 v212, v224, v225
    v_exp_f32 v227, v171
    v_exp_f32 v228, v172
    v_add_f32 v233, v233, v226
    v_add_f32 v233, v233, v227
    v_cvt_pk_bf16_f32 v213, v226, v227
    v_exp_f32 v229, v173
    v_exp_f32 v230, v174
    v_add_f32 v233, v233, v228
    v_add_f32 v233, v233, v229
    v_cvt_pk_bf16_f32 v214, v228, v229
    v_exp_f32 v231, v175
    v_add_f32 v233, v233, v230
    v_add_f32 v233, v233, v231
    v_cvt_pk_bf16_f32 v215, v230, v231
    s_nop 1
    s_branch L_rescb_14
L_resc_15:
    s_nop 15
    s_nop 7
    v_max3_f32 v237, v176, v177, v178
    v_max3_f32 v237, v237, v179, v180
    v_max3_f32 v237, v237, v181, v182
    v_max3_f32 v237, v237, v183, v184
    v_max3_f32 v237, v237, v185, v186
    v_max3_f32 v237, v237, v187, v188
    v_max3_f32 v237, v237, v189, v190
    v_max_f32 v237, v237, v191
    v_mov_b32 v235, v237
    s_nop 1
    v_permlane32_swap_b32 v235, v237
    v_max_f32 v237, v237, v235
    v_max_f32 v237, 0, v237
    v_add_f32 v234, v234, v237
    v_exp_f32 v238, -v237
    v_sub_f32 v192, 0, v234
    v_sub_f32 v193, 0, v234
    v_sub_f32 v194, 0, v234
    v_sub_f32 v195, 0, v234
    v_sub_f32 v196, 0, v234
    v_sub_f32 v197, 0, v234
    v_sub_f32 v198, 0, v234
    v_sub_f32 v199, 0, v234
    v_sub_f32 v200, 0, v234
    v_sub_f32 v201, 0, v234
    v_sub_f32 v202, 0, v234
    v_sub_f32 v203, 0, v234
    v_sub_f32 v204, 0, v234
    v_sub_f32 v205, 0, v234
    v_sub_f32 v206, 0, v234
    v_sub_f32 v207, 0, v234
    v_sub_f32 v176, v176, v237
    v_sub_f32 v177, v177, v237
    v_sub_f32 v178, v178, v237
    v_sub_f32 v179, v179, v237
    v_sub_f32 v180, v180, v237
    v_sub_f32 v181, v181, v237
    v_sub_f32 v182, v182, v237
    v_sub_f32 v183, v183, v237
    v_sub_f32 v184, v184, v237
    v_sub_f32 v185, v185, v237
    v_sub_f32 v186, v186, v237
    v_sub_f32 v187, v187, v237
    v_sub_f32 v188, v188, v237
    v_sub_f32 v189, v189, v237
    v_sub_f32 v190, v190, v237
    v_sub_f32 v191, v191, v237
    v_sub_f32 v160, v160, v237
    v_sub_f32 v161, v161, v237
    v_sub_f32 v162, v162, v237
    v_sub_f32 v163, v163, v237
    v_sub_f32 v164, v164, v237
    v_sub_f32 v165, v165, v237
    v_sub_f32 v166, v166, v237
    v_sub_f32 v167, v167, v237
    v_sub_f32 v168, v168, v237
    v_sub_f32 v169, v169, v237
    v_sub_f32 v170, v170, v237
    v_sub_f32 v171, v171, v237
    v_sub_f32 v172, v172, v237
    v_sub_f32 v173, v173, v237
    v_sub_f32 v174, v174, v237
    v_sub_f32 v175, v175, v237
    v_mul_f32 v232, v232, v238
    v_mul_f32 v64, v64, v238
    v_mul_f32 v65, v65, v238
    v_mul_f32 v66, v66, v238
    v_mul_f32 v67, v67, v238
    v_mul_f32 v68, v68, v238
    v_mul_f32 v69, v69, v238
    v_mul_f32 v70, v70, v238
    v_mul_f32 v71, v71, v238
    v_mul_f32 v72, v72, v238
    v_mul_f32 v73, v73, v238
    v_mul_f32 v74, v74, v238
    v_mul_f32 v75, v75, v238
    v_mul_f32 v76, v76, v238
    v_mul_f32 v77, v77, v238
    v_mul_f32 v78, v78, v238
    v_mul_f32 v79, v79, v238
    v_mul_f32 v80, v80, v238
    v_mul_f32 v81, v81, v238
    v_mul_f32 v82, v82, v238
    v_mul_f32 v83, v83, v238
    v_mul_f32 v84, v84, v238
    v_mul_f32 v85, v85, v238
    v_mul_f32 v86, v86, v238
    v_mul_f32 v87, v87, v238
    v_mul_f32 v88, v88, v238
    v_mul_f32 v89, v89, v238
    v_mul_f32 v90, v90, v238
    v_mul_f32 v91, v91, v238
    v_mul_f32 v92, v92, v238
    v_mul_f32 v93, v93, v238
    v_mul_f32 v94, v94, v238
    v_mul_f32 v95, v95, v238
    v_mul_f32 v96, v96, v238
    v_mul_f32 v97, v97, v238
    v_mul_f32 v98, v98, v238
    v_mul_f32 v99, v99, v238
    v_mul_f32 v100, v100, v238
    v_mul_f32 v101, v101, v238
    v_mul_f32 v102, v102, v238
    v_mul_f32 v103, v103, v238
    v_mul_f32 v104, v104, v238
    v_mul_f32 v105, v105, v238
    v_mul_f32 v106, v106, v238
    v_mul_f32 v107, v107, v238
    v_mul_f32 v108, v108, v238
    v_mul_f32 v109, v109, v238
    v_mul_f32 v110, v110, v238
    v_mul_f32 v111, v111, v238
    v_mul_f32 v112, v112, v238
    v_mul_f32 v113, v113, v238
    v_mul_f32 v114, v114, v238
    v_mul_f32 v115, v115, v238
    v_mul_f32 v116, v116, v238
    v_mul_f32 v117, v117, v238
    v_mul_f32 v118, v118, v238
    v_mul_f32 v119, v119, v238
    v_mul_f32 v120, v120, v238
    v_mul_f32 v121, v121, v238
    v_mul_f32 v122, v122, v238
    v_mul_f32 v123, v123, v238
    v_mul_f32 v124, v124, v238
    v_mul_f32 v125, v125, v238
    v_mul_f32 v126, v126, v238
    v_mul_f32 v127, v127, v238
    v_mul_f32 v128, v128, v238
    v_mul_f32 v129, v129, v238
    v_mul_f32 v130, v130, v238
    v_mul_f32 v131, v131, v238
    v_mul_f32 v132, v132, v238
    v_mul_f32 v133, v133, v238
    v_mul_f32 v134, v134, v238
    v_mul_f32 v135, v135, v238
    v_mul_f32 v136, v136, v238
    v_mul_f32 v137, v137, v238
    v_mul_f32 v138, v138, v238
    v_mul_f32 v139, v139, v238
    v_mul_f32 v140, v140, v238
    v_mul_f32 v141, v141, v238
    v_mul_f32 v142, v142, v238
    v_mul_f32 v143, v143, v238
    v_mul_f32 v144, v144, v238
    v_mul_f32 v145, v145, v238
    v_mul_f32 v146, v146, v238
    v_mul_f32 v147, v147, v238
    v_mul_f32 v148, v148, v238
    v_mul_f32 v149, v149, v238
    v_mul_f32 v150, v150, v238
    v_mul_f32 v151, v151, v238
    v_mul_f32 v152, v152, v238
    v_mul_f32 v153, v153, v238
    v_mul_f32 v154, v154, v238
    v_mul_f32 v155, v155, v238
    v_mul_f32 v156, v156, v238
    v_mul_f32 v157, v157, v238
    v_mul_f32 v158, v158, v238
    v_mul_f32 v159, v159, v238
    v_exp_f32 v224, v176
    v_exp_f32 v225, v177
    v_exp_f32 v226, v178
    v_add_f32 v233, v224, v225
    v_cvt_pk_bf16_f32 v216, v224, v225
    v_exp_f32 v227, v179
    v_exp_f32 v228, v180
    v_add_f32 v233, v233, v226
    v_add_f32 v233, v233, v227
    v_cvt_pk_bf16_f32 v217, v226, v227
    v_exp_f32 v229, v181
    v_exp_f32 v230, v182
    v_add_f32 v233, v233, v228
    v_add_f32 v233, v233, v229
    v_cvt_pk_bf16_f32 v218, v228, v229
    v_exp_f32 v231, v183
    v_exp_f32 v224, v184
    v_add_f32 v233, v233, v230
    v_add_f32 v233, v233, v231
    v_cvt_pk_bf16_f32 v219, v230, v231
    v_exp_f32 v225, v185
    v_exp_f32 v226, v186
    v_add_f32 v233, v233, v224
    v_add_f32 v233, v233, v225
    v_cvt_pk_bf16_f32 v220, v224, v225
    v_exp_f32 v227, v187
    v_exp_f32 v228, v188
    v_add_f32 v233, v233, v226
    v_add_f32 v233, v233, v227
    v_cvt_pk_bf16_f32 v221, v226, v227
    v_exp_f32 v229, v189
    v_exp_f32 v230, v190
    v_add_f32 v233, v233, v228
    v_add_f32 v233, v233, v229
    v_cvt_pk_bf16_f32 v222, v228, v229
    v_exp_f32 v231, v191
    v_add_f32 v233, v233, v230
    v_add_f32 v233, v233, v231
    v_cvt_pk_bf16_f32 v223, v230, v231
    s_nop 1
    s_branch L_rescb_16
L_resc_17:
    s_nop 15
    s_nop 7
    v_max3_f32 v237, v160, v161, v162
    v_max3_f32 v237, v237, v163, v164
    v_max3_f32 v237, v237, v165, v166
    v_max3_f32 v237, v237, v167, v168
    v_max3_f32 v237, v237, v169, v170
    v_max3_f32 v237, v237, v171, v172
    v_max3_f32 v237, v237, v173, v174
    v_max_f32 v237, v237, v175
    v_mov_b32 v235, v237
    s_nop 1
    v_permlane32_swap_b32 v235, v237
    v_max_f32 v237, v237, v235
    v_max_f32 v237, 0, v237
    v_add_f32 v234, v234, v237
    v_exp_f32 v238, -v237
    v_sub_f32 v192, 0, v234
    v_sub_f32 v193, 0, v234
    v_sub_f32 v194, 0, v234
    v_sub_f32 v195, 0, v234
    v_sub_f32 v196, 0, v234
    v_sub_f32 v197, 0, v234
    v_sub_f32 v198, 0, v234
    v_sub_f32 v199, 0, v234
    v_sub_f32 v200, 0, v234
    v_sub_f32 v201, 0, v234
    v_sub_f32 v202, 0, v234
    v_sub_f32 v203, 0, v234
    v_sub_f32 v204, 0, v234
    v_sub_f32 v205, 0, v234
    v_sub_f32 v206, 0, v234
    v_sub_f32 v207, 0, v234
    v_sub_f32 v160, v160, v237
    v_sub_f32 v161, v161, v237
    v_sub_f32 v162, v162, v237
    v_sub_f32 v163, v163, v237
    v_sub_f32 v164, v164, v237
    v_sub_f32 v165, v165, v237
    v_sub_f32 v166, v166, v237
    v_sub_f32 v167, v167, v237
    v_sub_f32 v168, v168, v237
    v_sub_f32 v169, v169, v237
    v_sub_f32 v170, v170, v237
    v_sub_f32 v171, v171, v237
    v_sub_f32 v172, v172, v237
    v_sub_f32 v173, v173, v237
    v_sub_f32 v174, v174, v237
    v_sub_f32 v175, v175, v237
    v_sub_f32 v176, v176, v237
    v_sub_f32 v177, v177, v237
    v_sub_f32 v178, v178, v237
    v_sub_f32 v179, v179, v237
    v_sub_f32 v180, v180, v237
    v_sub_f32 v181, v181, v237
    v_sub_f32 v182, v182, v237
    v_sub_f32 v183, v183, v237
    v_sub_f32 v184, v184, v237
    v_sub_f32 v185, v185, v237
    v_sub_f32 v186, v186, v237
    v_sub_f32 v187, v187, v237
    v_sub_f32 v188, v188, v237
    v_sub_f32 v189, v189, v237
    v_sub_f32 v190, v190, v237
    v_sub_f32 v191, v191, v237
    v_mul_f32 v232, v232, v238
    v_mul_f32 v64, v64, v238
    v_mul_f32 v65, v65, v238
    v_mul_f32 v66, v66, v238
    v_mul_f32 v67, v67, v238
    v_mul_f32 v68, v68, v238
    v_mul_f32 v69, v69, v238
    v_mul_f32 v70, v70, v238
    v_mul_f32 v71, v71, v238
    v_mul_f32 v72, v72, v238
    v_mul_f32 v73, v73, v238
    v_mul_f32 v74, v74, v238
    v_mul_f32 v75, v75, v238
    v_mul_f32 v76, v76, v238
    v_mul_f32 v77, v77, v238
    v_mul_f32 v78, v78, v238
    v_mul_f32 v79, v79, v238
    v_mul_f32 v80, v80, v238
    v_mul_f32 v81, v81, v238
    v_mul_f32 v82, v82, v238
    v_mul_f32 v83, v83, v238
    v_mul_f32 v84, v84, v238
    v_mul_f32 v85, v85, v238
    v_mul_f32 v86, v86, v238
    v_mul_f32 v87, v87, v238
    v_mul_f32 v88, v88, v238
    v_mul_f32 v89, v89, v238
    v_mul_f32 v90, v90, v238
    v_mul_f32 v91, v91, v238
    v_mul_f32 v92, v92, v238
    v_mul_f32 v93, v93, v238
    v_mul_f32 v94, v94, v238
    v_mul_f32 v95, v95, v238
    v_mul_f32 v96, v96, v238
    v_mul_f32 v97, v97, v238
    v_mul_f32 v98, v98, v238
    v_mul_f32 v99, v99, v238
    v_mul_f32 v100, v100, v238
    v_mul_f32 v101, v101, v238
    v_mul_f32 v102, v102, v238
    v_mul_f32 v103, v103, v238
    v_mul_f32 v104, v104, v238
    v_mul_f32 v105, v105, v238
    v_mul_f32 v106, v106, v238
    v_mul_f32 v107, v107, v238
    v_mul_f32 v108, v108, v238
    v_mul_f32 v109, v109, v238
    v_mul_f32 v110, v110, v238
    v_mul_f32 v111, v111, v238
    v_mul_f32 v112, v112, v238
    v_mul_f32 v113, v113, v238
    v_mul_f32 v114, v114, v238
    v_mul_f32 v115, v115, v238
    v_mul_f32 v116, v116, v238
    v_mul_f32 v117, v117, v238
    v_mul_f32 v118, v118, v238
    v_mul_f32 v119, v119, v238
    v_mul_f32 v120, v120, v238
    v_mul_f32 v121, v121, v238
    v_mul_f32 v122, v122, v238
    v_mul_f32 v123, v123, v238
    v_mul_f32 v124, v124, v238
    v_mul_f32 v125, v125, v238
    v_mul_f32 v126, v126, v238
    v_mul_f32 v127, v127, v238
    v_mul_f32 v128, v128, v238
    v_mul_f32 v129, v129, v238
    v_mul_f32 v130, v130, v238
    v_mul_f32 v131, v131, v238
    v_mul_f32 v132, v132, v238
    v_mul_f32 v133, v133, v238
    v_mul_f32 v134, v134, v238
    v_mul_f32 v135, v135, v238
    v_mul_f32 v136, v136, v238
    v_mul_f32 v137, v137, v238
    v_mul_f32 v138, v138, v238
    v_mul_f32 v139, v139, v238
    v_mul_f32 v140, v140, v238
    v_mul_f32 v141, v141, v238
    v_mul_f32 v142, v142, v238
    v_mul_f32 v143, v143, v238
    v_mul_f32 v144, v144, v238
    v_mul_f32 v145, v145, v238
    v_mul_f32 v146, v146, v238
    v_mul_f32 v147, v147, v238
    v_mul_f32 v148, v148, v238
    v_mul_f32 v149, v149, v238
    v_mul_f32 v150, v150, v238
    v_mul_f32 v151, v151, v238
    v_mul_f32 v152, v152, v238
    v_mul_f32 v153, v153, v238
    v_mul_f32 v154, v154, v238
    v_mul_f32 v155, v155, v238
    v_mul_f32 v156, v156, v238
    v_mul_f32 v157, v157, v238
    v_mul_f32 v158, v158, v238
    v_mul_f32 v159, v159, v238
    v_exp_f32 v224, v160
    v_exp_f32 v225, v161
    v_exp_f32 v226, v162
    v_add_f32 v233, v224, v225
    v_cvt_pk_bf16_f32 v208, v224, v225
    v_exp_f32 v227, v163
    v_exp_f32 v228, v164
    v_add_f32 v233, v233, v226
    v_add_f32 v233, v233, v227
    v_cvt_pk_bf16_f32 v209, v226, v227
    v_exp_f32 v229, v165
    v_exp_f32 v230, v166
    v_add_f32 v233, v233, v228
    v_add_f32 v233, v233, v229
    v_cvt_pk_bf16_f32 v210, v228, v229
    v_exp_f32 v231, v167
    v_exp_f32 v224, v168
    v_add_f32 v233, v233, v230
    v_add_f32 v233, v233, v231
    v_cvt_pk_bf16_f32 v211, v230, v231
    v_exp_f32 v225, v169
    v_exp_f32 v226, v170
    v_add_f32 v233, v233, v224
    v_add_f32 v233, v233, v225
    v_cvt_pk_bf16_f32 v212, v224, v225
    v_exp_f32 v227, v171
    v_exp_f32 v228, v172
    v_add_f32 v233, v233, v226
    v_add_f32 v233, v233, v227
    v_cvt_pk_bf16_f32 v213, v226, v227
    v_exp_f32 v229, v173
    v_exp_f32 v230, v174
    v_add_f32 v233, v233, v228
    v_add_f32 v233, v233, v229
    v_cvt_pk_bf16_f32 v214, v228, v229
    v_exp_f32 v231, v175
    v_add_f32 v233, v233, v230
    v_add_f32 v233, v233, v231
    v_cvt_pk_bf16_f32 v215, v230, v231
    s_nop 1
    s_branch L_rescb_18
L_resc_19:
    s_nop 15
    s_nop 7
    v_max3_f32 v237, v176, v177, v178
    v_max3_f32 v237, v237, v179, v180
    v_max3_f32 v237, v237, v181, v182
    v_max3_f32 v237, v237, v183, v184
    v_max3_f32 v237, v237, v185, v186
    v_max3_f32 v237, v237, v187, v188
    v_max3_f32 v237, v237, v189, v190
    v_max_f32 v237, v237, v191
    v_mov_b32 v235, v237
    s_nop 1
    v_permlane32_swap_b32 v235, v237
    v_max_f32 v237, v237, v235
    v_max_f32 v237, 0, v237
    v_add_f32 v234, v234, v237
    v_exp_f32 v238, -v237
    v_sub_f32 v192, 0, v234
    v_sub_f32 v193, 0, v234
    v_sub_f32 v194, 0, v234
    v_sub_f32 v195, 0, v234
    v_sub_f32 v196, 0, v234
    v_sub_f32 v197, 0, v234
    v_sub_f32 v198, 0, v234
    v_sub_f32 v199, 0, v234
    v_sub_f32 v200, 0, v234
    v_sub_f32 v201, 0, v234
    v_sub_f32 v202, 0, v234
    v_sub_f32 v203, 0, v234
    v_sub_f32 v204, 0, v234
    v_sub_f32 v205, 0, v234
    v_sub_f32 v206, 0, v234
    v_sub_f32 v207, 0, v234
    v_sub_f32 v176, v176, v237
    v_sub_f32 v177, v177, v237
    v_sub_f32 v178, v178, v237
    v_sub_f32 v179, v179, v237
    v_sub_f32 v180, v180, v237
    v_sub_f32 v181, v181, v237
    v_sub_f32 v182, v182, v237
    v_sub_f32 v183, v183, v237
    v_sub_f32 v184, v184, v237
    v_sub_f32 v185, v185, v237
    v_sub_f32 v186, v186, v237
    v_sub_f32 v187, v187, v237
    v_sub_f32 v188, v188, v237
    v_sub_f32 v189, v189, v237
    v_sub_f32 v190, v190, v237
    v_sub_f32 v191, v191, v237
    v_mul_f32 v232, v232, v238
    v_mul_f32 v64, v64, v238
    v_mul_f32 v65, v65, v238
    v_mul_f32 v66, v66, v238
    v_mul_f32 v67, v67, v238
    v_mul_f32 v68, v68, v238
    v_mul_f32 v69, v69, v238
    v_mul_f32 v70, v70, v238
    v_mul_f32 v71, v71, v238
    v_mul_f32 v72, v72, v238
    v_mul_f32 v73, v73, v238
    v_mul_f32 v74, v74, v238
    v_mul_f32 v75, v75, v238
    v_mul_f32 v76, v76, v238
    v_mul_f32 v77, v77, v238
    v_mul_f32 v78, v78, v238
    v_mul_f32 v79, v79, v238
    v_mul_f32 v80, v80, v238
    v_mul_f32 v81, v81, v238
    v_mul_f32 v82, v82, v238
    v_mul_f32 v83, v83, v238
    v_mul_f32 v84, v84, v238
    v_mul_f32 v85, v85, v238
    v_mul_f32 v86, v86, v238
    v_mul_f32 v87, v87, v238
    v_mul_f32 v88, v88, v238
    v_mul_f32 v89, v89, v238
    v_mul_f32 v90, v90, v238
    v_mul_f32 v91, v91, v238
    v_mul_f32 v92, v92, v238
    v_mul_f32 v93, v93, v238
    v_mul_f32 v94, v94, v238
    v_mul_f32 v95, v95, v238
    v_mul_f32 v96, v96, v238
    v_mul_f32 v97, v97, v238
    v_mul_f32 v98, v98, v238
    v_mul_f32 v99, v99, v238
    v_mul_f32 v100, v100, v238
    v_mul_f32 v101, v101, v238
    v_mul_f32 v102, v102, v238
    v_mul_f32 v103, v103, v238
    v_mul_f32 v104, v104, v238
    v_mul_f32 v105, v105, v238
    v_mul_f32 v106, v106, v238
    v_mul_f32 v107, v107, v238
    v_mul_f32 v108, v108, v238
    v_mul_f32 v109, v109, v238
    v_mul_f32 v110, v110, v238
    v_mul_f32 v111, v111, v238
    v_mul_f32 v112, v112, v238
    v_mul_f32 v113, v113, v238
    v_mul_f32 v114, v114, v238
    v_mul_f32 v115, v115, v238
    v_mul_f32 v116, v116, v238
    v_mul_f32 v117, v117, v238
    v_mul_f32 v118, v118, v238
    v_mul_f32 v119, v119, v238
    v_mul_f32 v120, v120, v238
    v_mul_f32 v121, v121, v238
    v_mul_f32 v122, v122, v238
    v_mul_f32 v123, v123, v238
    v_mul_f32 v124, v124, v238
    v_mul_f32 v125, v125, v238
    v_mul_f32 v126, v126, v238
    v_mul_f32 v127, v127, v238
    v_mul_f32 v128, v128, v238
    v_mul_f32 v129, v129, v238
    v_mul_f32 v130, v130, v238
    v_mul_f32 v131, v131, v238
    v_mul_f32 v132, v132, v238
    v_mul_f32 v133, v133, v238
    v_mul_f32 v134, v134, v238
    v_mul_f32 v135, v135, v238
    v_mul_f32 v136, v136, v238
    v_mul_f32 v137, v137, v238
    v_mul_f32 v138, v138, v238
    v_mul_f32 v139, v139, v238
    v_mul_f32 v140, v140, v238
    v_mul_f32 v141, v141, v238
    v_mul_f32 v142, v142, v238
    v_mul_f32 v143, v143, v238
    v_mul_f32 v144, v144, v238
    v_mul_f32 v145, v145, v238
    v_mul_f32 v146, v146, v238
    v_mul_f32 v147, v147, v238
    v_mul_f32 v148, v148, v238
    v_mul_f32 v149, v149, v238
    v_mul_f32 v150, v150, v238
    v_mul_f32 v151, v151, v238
    v_mul_f32 v152, v152, v238
    v_mul_f32 v153, v153, v238
    v_mul_f32 v154, v154, v238
    v_mul_f32 v155, v155, v238
    v_mul_f32 v156, v156, v238
    v_mul_f32 v157, v157, v238
    v_mul_f32 v158, v158, v238
    v_mul_f32 v159, v159, v238
    v_exp_f32 v224, v176
    v_exp_f32 v225, v177
    v_exp_f32 v226, v178
    v_add_f32 v233, v224, v225
    v_cvt_pk_bf16_f32 v216, v224, v225
    v_exp_f32 v227, v179
    v_exp_f32 v228, v180
    v_add_f32 v233, v233, v226
    v_add_f32 v233, v233, v227
    v_cvt_pk_bf16_f32 v217, v226, v227
    v_exp_f32 v229, v181
    v_exp_f32 v230, v182
    v_add_f32 v233, v233, v228
    v_add_f32 v233, v233, v229
    v_cvt_pk_bf16_f32 v218, v228, v229
    v_exp_f32 v231, v183
    v_exp_f32 v224, v184
    v_add_f32 v233, v233, v230
    v_add_f32 v233, v233, v231
    v_cvt_pk_bf16_f32 v219, v230, v231
    v_exp_f32 v225, v185
    v_exp_f32 v226, v186
    v_add_f32 v233, v233, v224
    v_add_f32 v233, v233, v225
    v_cvt_pk_bf16_f32 v220, v224, v225
    v_exp_f32 v227, v187
    v_exp_f32 v228, v188
    v_add_f32 v233, v233, v226
    v_add_f32 v233, v233, v227
    v_cvt_pk_bf16_f32 v221, v226, v227
    v_exp_f32 v229, v189
    v_exp_f32 v230, v190
    v_add_f32 v233, v233, v228
    v_add_f32 v233, v233, v229
    v_cvt_pk_bf16_f32 v222, v228, v229
    v_exp_f32 v231, v191
    v_add_f32 v233, v233, v230
    v_add_f32 v233, v233, v231
    v_cvt_pk_bf16_f32 v223, v230, v231
    s_nop 1
    s_branch L_rescb_20
.section .rodata,"a"
.p2align 6
.amdhsa_kernel standalone__video_timesformer__vision_kernel
  .amdhsa_next_free_vgpr 512
  .amdhsa_next_free_sgpr 102
  .amdhsa_accum_offset 256
  .amdhsa_group_segment_fixed_size 0
  .amdhsa_kernarg_size 64
  .amdhsa_user_sgpr_count 2
  .amdhsa_user_sgpr_kernarg_segment_ptr 1
  .amdhsa_system_sgpr_workgroup_id_x 1
.end_amdhsa_kernel
```
